```python
import torch

def _softmax(x, axis=-1):
    return torch.softmax(x, dim=axis)
def _gelu(x):
    return torch.nn.functional.gelu(x, approximate="tanh")
def _silu(x):
    return torch.nn.functional.silu(x)
def _sigmoid(x):
    return torch.sigmoid(x)
def _layernorm(x, axis=-1, eps=1e-5):
    m = x.mean(dim=axis, keepdim=True)
    v = x.var(dim=axis, keepdim=True, unbiased=False)
    return (x - m) / torch.sqrt(v + eps)
def _scatter_add(tgt, idx, src, axis=0):
    return tgt.clone().index_add_(axis, idx, src)
def _segment_sum(src, seg, n):
    out = torch.zeros((n,) + src.shape[1:], dtype=src.dtype)
    return out.index_add_(0, seg, src)
def _pad(x, pw):
    flat = tuple(v for pair in reversed(pw) for v in pair)
    return torch.nn.functional.pad(x, flat)

kernel_name = 'parallel_sum__spectral_fnet__geglu_ffn__prompt'

def setup_inputs():

    _w = (lambda a: (lambda t: t.to(torch.bfloat16) if t.is_floating_point() else t)(torch.as_tensor(a)))
    def _A_setup():
        B, S, D = 1, 2048, 512
        ns = torch.arange(S)[:, None] * torch.arange(S)[None, :]
        nd = torch.arange(D)[:, None] * torch.arange(D)[None, :]
        Ws_re = torch.cos(-2.0 * torch.pi * ns / S).to(float)
        Ws_im = torch.sin(-2.0 * torch.pi * ns / S).to(float)
        Wd_re = torch.cos(-2.0 * torch.pi * nd / D).to(float)
        Wd_im = torch.sin(-2.0 * torch.pi * nd / D).to(float)
        return {
            "x": _w((lambda *s: torch.randn(*s, dtype=torch.bfloat16) * 0.05)(B, S, D)),
            "dft_seq_re": _w(Ws_re),
            "dft_seq_im": _w(Ws_im),
            "dft_hid_re": _w(Wd_re),
            "dft_hid_im": _w(Wd_im),
        }
    _A_in = _A_setup()

    def _B_setup():
        B, S, D, F = 1, 2048, 512, 1376
        return {
            "x": _w((lambda *s: torch.randn(*s, dtype=torch.bfloat16) * 0.05)(B, S, D)),
            "w_gate": _w((lambda *s: torch.randn(*s, dtype=torch.bfloat16) * 0.2)(D, F)),
            "w_up": _w((lambda *s: torch.randn(*s, dtype=torch.bfloat16) * 0.2)(D, F)),
            "w_down": _w((lambda *s: torch.randn(*s, dtype=torch.bfloat16) * 0.2)(F, D)),
        }
    _B_in = _B_setup()

    return {
        "A_x": _A_in["x"],
        "A_dft_seq_re": _A_in["dft_seq_re"],
        "A_dft_seq_im": _A_in["dft_seq_im"],
        "A_dft_hid_re": _A_in["dft_hid_re"],
        "A_dft_hid_im": _A_in["dft_hid_im"],
        "B_x": _B_in["x"],
        "B_w_gate": _B_in["w_gate"],
        "B_w_up": _B_in["w_up"],
        "B_w_down": _B_in["w_down"],
    }

def reference(A_x, A_dft_seq_re, A_dft_seq_im, A_dft_hid_re, A_dft_hid_im, B_x, B_w_gate, B_w_up, B_w_down):
    def _A_ref(x, dft_seq_re, dft_seq_im, dft_hid_re, dft_hid_im):
        a = torch.einsum("bsd,ed->bse", x, dft_hid_re)
        b = torch.einsum("bsd,ed->bse", x, dft_hid_im)
        y = torch.einsum("ts,bse->bte", dft_seq_re, a) - torch.einsum("ts,bse->bte", dft_seq_im, b)
        return y

    def _B_ref(x, w_gate, w_up, w_down):
        return (_gelu(x @ w_gate) * (x @ w_up)) @ w_down

    x = A_x
    xn = _layernorm(x, axis=-1)
    return x + _A_ref(xn, A_dft_seq_re, A_dft_seq_im, A_dft_hid_re, A_dft_hid_im) + _B_ref(xn, B_w_gate, B_w_up, B_w_down)
```

```asm
; @launch kernel=prep_kernel grid=(1216,1,1) block=(256,1,1) lds=0
; @launch kernel=gemm1_kernel grid=(240,1,1) block=(512,1,1) lds=147456
; @launch kernel=gemm2_kernel grid=(256,1,1) block=(512,1,1) lds=131072
.amdgcn_target "amdgcn-amd-amdhsa--gfx950"
.text
.globl prep_kernel
.p2align 8
.type prep_kernel,@function
prep_kernel:
    s_cmp_ge_u32 s2, 1216
    s_cbranch_scc1 L_prep_end
    s_load_dwordx2 s[4:5], s[0:1], 0
    s_load_dwordx4 s[8:11], s[0:1], 48
    s_load_dwordx2 s[12:13], s[0:1], 64
    s_load_dwordx2 s[14:15], s[0:1], 88
    v_lshrrev_b32 v1, 6, v0
    v_and_b32 v2, 63, v0
    s_nop 0
    v_readfirstlane_b32 s3, v1
    s_lshl_b32 s16, s2, 2
    s_nop 3
    s_add_u32 s16, s16, s3
    s_waitcnt lgkmcnt(0)

    s_cmp_lt_u32 s16, 0
    s_cbranch_scc1 L_prep_pf
    s_sub_u32 s16, s16, 0
    s_add_u32 s16, s16, 2048
    s_cmp_lt_u32 s16, 4864
    s_cbranch_scc1 L_prep_wgu
    s_sub_u32 s16, s16, 4864

    s_mov_b32 s20, s4
    s_mov_b32 s21, s5
    s_mov_b32 s22, 2097152
    s_mov_b32 s23, 0x00020000
    s_mov_b32 s24, s14
    s_mov_b32 s25, s15
    s_mov_b32 s26, 2097152
    s_mov_b32 s27, 0x00020000
    s_lshl_b32 s17, s16, 10
    v_lshlrev_b32 v3, 4, v2
    buffer_load_dwordx4 v[4:7], v3, s[20:23], s17 offen
    s_cmp_lg_u32 s16, 0
    s_cbranch_scc1 L_prep_noflag

    s_add_u32 s28, s14, 31457280
    s_addc_u32 s29, s15, 0
    s_mov_b32 s30, 16384
    s_mov_b32 s31, 0x00020000
    v_mov_b32 v8, 0
    v_mov_b32 v9, 0
    v_mov_b32 v10, 0
    v_mov_b32 v11, 0
    s_mov_b32 s32, 0

    buffer_store_dwordx4 v[8:11], v3, s[28:31], s32 offen
    s_add_u32 s32, s32, 1024
    buffer_store_dwordx4 v[8:11], v3, s[28:31], s32 offen
    s_add_u32 s32, s32, 1024
    buffer_store_dwordx4 v[8:11], v3, s[28:31], s32 offen
    s_add_u32 s32, s32, 1024
    buffer_store_dwordx4 v[8:11], v3, s[28:31], s32 offen
    s_add_u32 s32, s32, 1024
    buffer_store_dwordx4 v[8:11], v3, s[28:31], s32 offen
    s_add_u32 s32, s32, 1024
    buffer_store_dwordx4 v[8:11], v3, s[28:31], s32 offen
    s_add_u32 s32, s32, 1024
    buffer_store_dwordx4 v[8:11], v3, s[28:31], s32 offen
    s_add_u32 s32, s32, 1024
    buffer_store_dwordx4 v[8:11], v3, s[28:31], s32 offen
    s_add_u32 s32, s32, 1024
    buffer_store_dwordx4 v[8:11], v3, s[28:31], s32 offen
    s_add_u32 s32, s32, 1024
    buffer_store_dwordx4 v[8:11], v3, s[28:31], s32 offen
    s_add_u32 s32, s32, 1024
    buffer_store_dwordx4 v[8:11], v3, s[28:31], s32 offen
    s_add_u32 s32, s32, 1024
    buffer_store_dwordx4 v[8:11], v3, s[28:31], s32 offen
    s_add_u32 s32, s32, 1024
    buffer_store_dwordx4 v[8:11], v3, s[28:31], s32 offen
    s_add_u32 s32, s32, 1024
    buffer_store_dwordx4 v[8:11], v3, s[28:31], s32 offen
    s_add_u32 s32, s32, 1024
    buffer_store_dwordx4 v[8:11], v3, s[28:31], s32 offen
    s_add_u32 s32, s32, 1024
    buffer_store_dwordx4 v[8:11], v3, s[28:31], s32 offen
    s_add_u32 s32, s32, 1024
L_prep_noflag:
    v_lshlrev_b32 v30, 2, v2
    v_xor_b32 v31, 4, v30
    v_xor_b32 v32, 8, v30
    v_xor_b32 v33, 16, v30
    v_xor_b32 v34, 32, v30
    v_xor_b32 v35, 64, v30
    v_xor_b32 v36, 128, v30
    s_waitcnt vmcnt(0)

    v_lshlrev_b32 v8, 16, v4
    v_and_b32 v9, 0xffff0000, v4
    v_lshlrev_b32 v10, 16, v5
    v_and_b32 v11, 0xffff0000, v5
    v_lshlrev_b32 v12, 16, v6
    v_and_b32 v13, 0xffff0000, v6
    v_lshlrev_b32 v14, 16, v7
    v_and_b32 v15, 0xffff0000, v7
    v_add_f32 v16, v8, v9
    v_add_f32 v17, v10, v11
    v_add_f32 v18, v12, v13
    v_add_f32 v19, v14, v15
    v_add_f32 v16, v16, v17
    v_add_f32 v18, v18, v19
    v_add_f32 v16, v16, v18

    ds_bpermute_b32 v17, v31, v16
    s_waitcnt lgkmcnt(0)
    v_add_f32 v16, v16, v17

    ds_bpermute_b32 v17, v32, v16
    s_waitcnt lgkmcnt(0)
    v_add_f32 v16, v16, v17

    ds_bpermute_b32 v17, v33, v16
    s_waitcnt lgkmcnt(0)
    v_add_f32 v16, v16, v17

    ds_bpermute_b32 v17, v34, v16
    s_waitcnt lgkmcnt(0)
    v_add_f32 v16, v16, v17

    ds_bpermute_b32 v17, v35, v16
    s_waitcnt lgkmcnt(0)
    v_add_f32 v16, v16, v17

    ds_bpermute_b32 v17, v36, v16
    s_waitcnt lgkmcnt(0)
    v_add_f32 v16, v16, v17

    v_mul_f32 v16, 0x3b000000, v16
    v_sub_f32 v20, v8, v16
    v_sub_f32 v21, v9, v16
    v_sub_f32 v22, v10, v16
    v_sub_f32 v23, v11, v16
    v_sub_f32 v24, v12, v16
    v_sub_f32 v25, v13, v16
    v_sub_f32 v26, v14, v16
    v_sub_f32 v27, v15, v16
    v_mul_f32 v17, v20, v20
    v_fmac_f32 v17, v21, v21
    v_fmac_f32 v17, v22, v22
    v_fmac_f32 v17, v23, v23
    v_fmac_f32 v17, v24, v24
    v_fmac_f32 v17, v25, v25
    v_fmac_f32 v17, v26, v26
    v_fmac_f32 v17, v27, v27
    ds_bpermute_b32 v18, v31, v17
    s_waitcnt lgkmcnt(0)
    v_add_f32 v17, v17, v18

    ds_bpermute_b32 v18, v32, v17
    s_waitcnt lgkmcnt(0)
    v_add_f32 v17, v17, v18

    ds_bpermute_b32 v18, v33, v17
    s_waitcnt lgkmcnt(0)
    v_add_f32 v17, v17, v18

    ds_bpermute_b32 v18, v34, v17
    s_waitcnt lgkmcnt(0)
    v_add_f32 v17, v17, v18

    ds_bpermute_b32 v18, v35, v17
    s_waitcnt lgkmcnt(0)
    v_add_f32 v17, v17, v18

    ds_bpermute_b32 v18, v36, v17
    s_waitcnt lgkmcnt(0)
    v_add_f32 v17, v17, v18

    v_mul_f32 v17, 0x3b000000, v17
    v_cvt_pk_bf16_f32 v18, v16, v17
    v_lshlrev_b32 v16, 16, v18
    v_and_b32 v17, 0xffff0000, v18
    v_add_f32 v17, 0x3727c5ac, v17
    v_cvt_pk_bf16_f32 v18, v17, v17
    v_lshlrev_b32 v17, 16, v18
    v_sqrt_f32 v17, v17
    s_nop 0
    v_cvt_pk_bf16_f32 v18, v17, v17
    v_lshlrev_b32 v17, 16, v18
    v_rcp_f32 v19, v17

    v_sub_f32 v20, v8, v16
    v_sub_f32 v21, v9, v16
    v_sub_f32 v22, v10, v16
    v_sub_f32 v23, v11, v16
    v_sub_f32 v24, v12, v16
    v_sub_f32 v25, v13, v16
    v_sub_f32 v26, v14, v16
    v_sub_f32 v27, v15, v16
    v_cvt_pk_bf16_f32 v4, v20, v21
    v_cvt_pk_bf16_f32 v5, v22, v23
    v_cvt_pk_bf16_f32 v6, v24, v25
    v_cvt_pk_bf16_f32 v7, v26, v27
    v_lshlrev_b32 v8, 16, v4
    v_and_b32 v9, 0xffff0000, v4
    v_lshlrev_b32 v10, 16, v5
    v_and_b32 v11, 0xffff0000, v5
    v_lshlrev_b32 v12, 16, v6
    v_and_b32 v13, 0xffff0000, v6
    v_lshlrev_b32 v14, 16, v7
    v_and_b32 v15, 0xffff0000, v7
    v_mul_f32 v20, v8, v19
    v_mul_f32 v21, v9, v19
    v_mul_f32 v22, v10, v19
    v_mul_f32 v23, v11, v19
    v_mul_f32 v24, v12, v19
    v_mul_f32 v25, v13, v19
    v_mul_f32 v26, v14, v19
    v_mul_f32 v27, v15, v19
    v_fma_f32 v8, -v20, v17, v8
    v_fma_f32 v9, -v21, v17, v9
    v_fma_f32 v10, -v22, v17, v10
    v_fma_f32 v11, -v23, v17, v11
    v_fma_f32 v12, -v24, v17, v12
    v_fma_f32 v13, -v25, v17, v13
    v_fma_f32 v14, -v26, v17, v14
    v_fma_f32 v15, -v27, v17, v15
    v_fmac_f32 v20, v8, v19
    v_fmac_f32 v21, v9, v19
    v_fmac_f32 v22, v10, v19
    v_fmac_f32 v23, v11, v19
    v_fmac_f32 v24, v12, v19
    v_fmac_f32 v25, v13, v19
    v_fmac_f32 v26, v14, v19
    v_fmac_f32 v27, v15, v19
    v_cvt_pk_bf16_f32 v4, v20, v21
    v_cvt_pk_bf16_f32 v5, v22, v23
    v_cvt_pk_bf16_f32 v6, v24, v25
    v_cvt_pk_bf16_f32 v7, v26, v27
    buffer_store_dwordx4 v[4:7], v3, s[24:27], s17 offen

    s_endpgm
L_prep_wgu:
    s_cmp_ge_u32 s16, 3456
    s_cbranch_scc1 L_prep_wd
    s_sub_u32 s16, s16, 2048
    s_lshr_b32 s17, s16, 6
    s_and_b32 s18, s16, 63

    s_mov_b32 s20, s8
    s_mov_b32 s21, s9
    s_mov_b32 s22, 1409024
    s_mov_b32 s23, 0x00020000
    s_mov_b32 s24, s10
    s_mov_b32 s25, s11
    s_mov_b32 s26, 1409024
    s_mov_b32 s27, 0x00020000
    s_add_u32 s28, s14, 2097152
    s_addc_u32 s29, s15, 0
    s_mov_b32 s30, 2883584
    s_mov_b32 s31, 0x00020000
    s_lshl_b32 s19, s17, 6
    v_add_u32 v3, s19, v2
    v_lshlrev_b32 v4, 1, v3
    s_mul_i32 s32, s18, 22016

    buffer_load_ushort v16, v4, s[20:23], s32 offen
    buffer_load_ushort v24, v4, s[24:27], s32 offen
    s_add_u32 s32, s32, 2752
    buffer_load_ushort v17, v4, s[20:23], s32 offen
    buffer_load_ushort v25, v4, s[24:27], s32 offen
    s_add_u32 s32, s32, 2752
    buffer_load_ushort v18, v4, s[20:23], s32 offen
    buffer_load_ushort v26, v4, s[24:27], s32 offen
    s_add_u32 s32, s32, 2752
    buffer_load_ushort v19, v4, s[20:23], s32 offen
    buffer_load_ushort v27, v4, s[24:27], s32 offen
    s_add_u32 s32, s32, 2752
    buffer_load_ushort v20, v4, s[20:23], s32 offen
    buffer_load_ushort v28, v4, s[24:27], s32 offen
    s_add_u32 s32, s32, 2752
    buffer_load_ushort v21, v4, s[20:23], s32 offen
    buffer_load_ushort v29, v4, s[24:27], s32 offen
    s_add_u32 s32, s32, 2752
    buffer_load_ushort v22, v4, s[20:23], s32 offen
    buffer_load_ushort v30, v4, s[24:27], s32 offen
    s_add_u32 s32, s32, 2752
    buffer_load_ushort v23, v4, s[20:23], s32 offen
    buffer_load_ushort v31, v4, s[24:27], s32 offen
    v_lshrrev_b32 v5, 5, v3
    v_lshlrev_b32 v5, 6, v5
    v_and_b32 v6, 31, v3
    v_add_u32 v5, v5, v6
    v_lshlrev_b32 v5, 10, v5
    s_lshl_b32 s33, s18, 4
    v_mov_b32 v7, 1376
    v_cmp_gt_u32 vcc, v7, v3
    s_waitcnt vmcnt(0)

    v_lshl_or_b32 v8, v17, 16, v16
    v_lshl_or_b32 v9, v19, 16, v18
    v_lshl_or_b32 v10, v21, 16, v20
    v_lshl_or_b32 v11, v23, 16, v22
    v_lshl_or_b32 v12, v25, 16, v24
    v_lshl_or_b32 v13, v27, 16, v26
    v_lshl_or_b32 v14, v29, 16, v28
    v_lshl_or_b32 v15, v31, 16, v30
    v_cndmask_b32 v8, 0, v8, vcc
    v_cndmask_b32 v9, 0, v9, vcc
    v_cndmask_b32 v10, 0, v10, vcc
    v_cndmask_b32 v11, 0, v11, vcc
    v_cndmask_b32 v12, 0, v12, vcc
    v_cndmask_b32 v13, 0, v13, vcc
    v_cndmask_b32 v14, 0, v14, vcc
    v_cndmask_b32 v15, 0, v15, vcc
    buffer_store_dwordx4 v[8:11], v5, s[28:31], s33 offen
    s_add_u32 s33, s33, 32768
    buffer_store_dwordx4 v[12:15], v5, s[28:31], s33 offen

    s_endpgm
L_prep_wd:
    s_sub_u32 s16, s16, 3456
    s_mul_hi_u32 s17, s16, 24403224
    s_mul_i32 s18, s17, 176
    s_sub_u32 s18, s16, s18

    s_mov_b32 s20, s12
    s_mov_b32 s21, s13
    s_mov_b32 s22, 1409024
    s_mov_b32 s23, 0x00020000
    s_add_u32 s28, s14, 12582912
    s_addc_u32 s29, s15, 0
    s_mov_b32 s30, 2097152
    s_mov_b32 s31, 0x00020000
    s_lshl_b32 s19, s17, 6
    v_add_u32 v3, s19, v2
    v_lshlrev_b32 v4, 1, v3
    s_lshl_b32 s32, s18, 13

    buffer_load_ushort v16, v4, s[20:23], s32 offen
    s_add_u32 s32, s32, 1024
    buffer_load_ushort v17, v4, s[20:23], s32 offen
    s_add_u32 s32, s32, 1024
    buffer_load_ushort v18, v4, s[20:23], s32 offen
    s_add_u32 s32, s32, 1024
    buffer_load_ushort v19, v4, s[20:23], s32 offen
    s_add_u32 s32, s32, 1024
    buffer_load_ushort v20, v4, s[20:23], s32 offen
    s_add_u32 s32, s32, 1024
    buffer_load_ushort v21, v4, s[20:23], s32 offen
    s_add_u32 s32, s32, 1024
    buffer_load_ushort v22, v4, s[20:23], s32 offen
    s_add_u32 s32, s32, 1024
    buffer_load_ushort v23, v4, s[20:23], s32 offen
    v_lshlrev_b32 v5, 12, v3
    s_lshl_b32 s33, s18, 4
    s_waitcnt vmcnt(0)

    v_lshl_or_b32 v8, v17, 16, v16
    v_lshl_or_b32 v9, v19, 16, v18
    v_lshl_or_b32 v10, v21, 16, v20
    v_lshl_or_b32 v11, v23, 16, v22
    buffer_store_dwordx4 v[8:11], v5, s[28:31], s33 offen

    s_endpgm
L_prep_pf:
    s_load_dwordx4 s[20:23], s[0:1], 8
    s_lshl_b32 s17, s16, 13
    v_lshlrev_b32 v3, 4, v2
    s_waitcnt lgkmcnt(0)

    s_mov_b32 s24, s20
    s_mov_b32 s25, s21
    s_mov_b32 s26, 8388608
    s_mov_b32 s27, 0x00020000
    s_mov_b32 s28, s22
    s_mov_b32 s29, s23
    s_mov_b32 s30, 8388608
    s_mov_b32 s31, 0x00020000
    buffer_load_dwordx4 v[4:7], v3, s[24:27], s17 offen
    buffer_load_dwordx4 v[20:23], v3, s[28:31], s17 offen
    s_add_u32 s17, s17, 1024
    buffer_load_dwordx4 v[8:11], v3, s[24:27], s17 offen
    buffer_load_dwordx4 v[24:27], v3, s[28:31], s17 offen
    s_add_u32 s17, s17, 1024
    buffer_load_dwordx4 v[12:15], v3, s[24:27], s17 offen
    buffer_load_dwordx4 v[28:31], v3, s[28:31], s17 offen
    s_add_u32 s17, s17, 1024
    buffer_load_dwordx4 v[16:19], v3, s[24:27], s17 offen
    buffer_load_dwordx4 v[32:35], v3, s[28:31], s17 offen
    s_add_u32 s17, s17, 1024
    buffer_load_dwordx4 v[4:7], v3, s[24:27], s17 offen
    buffer_load_dwordx4 v[20:23], v3, s[28:31], s17 offen
    s_add_u32 s17, s17, 1024
    buffer_load_dwordx4 v[8:11], v3, s[24:27], s17 offen
    buffer_load_dwordx4 v[24:27], v3, s[28:31], s17 offen
    s_add_u32 s17, s17, 1024
    buffer_load_dwordx4 v[12:15], v3, s[24:27], s17 offen
    buffer_load_dwordx4 v[28:31], v3, s[28:31], s17 offen
    s_add_u32 s17, s17, 1024
    buffer_load_dwordx4 v[16:19], v3, s[24:27], s17 offen
    buffer_load_dwordx4 v[32:35], v3, s[28:31], s17 offen
    s_add_u32 s17, s17, 1024
L_prep_end:
    s_endpgm
.globl gemm1_kernel
.p2align 8
.type gemm1_kernel,@function
gemm1_kernel:
    s_cmp_ge_u32 s2, 240
    s_cbranch_scc1 L_g1_end

    s_cmp_ge_u32 s2, 240
    s_cbranch_scc1 L_g1_pf
    s_load_dwordx4 s[40:43], s[0:1], 24
    s_load_dwordx2 s[44:45], s[0:1], 88
    s_waitcnt lgkmcnt(0)
    s_cmp_ge_u32 s2, 64
    s_cbranch_scc1 L_g1_ffn

    s_mov_b32 s4, s44
    s_mov_b32 s5, s45
    s_mov_b32 s6, 2097152
    s_mov_b32 s7, 0x00020000
    s_lshr_b32 s21, s2, 3
    s_and_b32 s24, s2, 7
    s_lshl_b32 s24, s24, 8
    s_cmp_ge_u32 s21, 4
    s_cselect_b64 s[46:47], s[42:43], s[40:41]
    s_and_b32 s25, s21, 3
    s_lshl_b32 s25, s25, 7

    s_mov_b32 s8, s46
    s_mov_b32 s9, s47
    s_mov_b32 s10, 524288
    s_mov_b32 s11, 0x00020000
    s_branch L_g1_main
L_g1_ffn:
    s_add_u32 s4, s44, 2097152
    s_addc_u32 s5, s45, 0
    s_mov_b32 s6, 2883584
    s_mov_b32 s7, 0x00020000
    s_mov_b32 s8, s44
    s_mov_b32 s9, s45
    s_mov_b32 s10, 2097152
    s_mov_b32 s11, 0x00020000
    s_sub_u32 s23, s2, 64
    s_and_b32 s25, s23, 15
    s_lshl_b32 s25, s25, 7
    s_lshr_b32 s24, s23, 4
    s_lshl_b32 s24, s24, 8
    s_mov_b32 s21, 8

L_g1_main:
    s_mov_b32 s26, s6
    s_mov_b32 s27, s10
    s_mov_b32 s17, 0
    s_mov_b32 s18, 8
    s_mov_b32 s16, 8

    v_and_b32 v1, 63, v0
    v_lshrrev_b32 v2, 6, v0
    s_nop 0
    v_readfirstlane_b32 s19, v2
    s_nop 3
    s_mov_b32 s15, 0
    s_cmp_lt_u32 s19, 4
    s_cbranch_scc1 L_g1_compute

    s_sub_u32 s14, s19, 4
    s_lshl_b32 s39, s14, 12
    s_mul_i32 s30, s14, 64
    s_lshl_b32 s31, s14, 5
    s_mul_i32 s14, s14, 8192
    v_lshrrev_b32 v20, 3, v1
    v_and_b32 v22, 7, v1
    v_lshrrev_b32 v23, 4, v1
    v_xor_b32 v22, v22, v23

    v_add_u32 v24, s24, v20
    v_add_u32 v24, s30, v24
    v_lshlrev_b32 v24, 10, v24
    v_mov_b32 v25, v22
    v_lshlrev_b32 v25, 4, v25
    v_add_u32 v4, v24, v25
    v_add_u32 v24, s24, v20
    v_add_u32 v24, s30, v24
    v_add_u32 v24, 8, v24
    v_lshlrev_b32 v24, 10, v24
    v_xor_b32 v25, 4, v22
    v_lshlrev_b32 v25, 4, v25
    v_add_u32 v5, v24, v25
    v_subrev_u32 v5, 1024, v5
    v_add_u32 v24, s24, v20
    v_add_u32 v24, s30, v24
    v_add_u32 v24, 16, v24
    v_lshlrev_b32 v24, 10, v24
    v_mov_b32 v25, v22
    v_lshlrev_b32 v25, 4, v25
    v_add_u32 v6, v24, v25
    v_subrev_u32 v6, 2048, v6
    v_add_u32 v24, s24, v20
    v_add_u32 v24, s30, v24
    v_add_u32 v24, 24, v24
    v_lshlrev_b32 v24, 10, v24
    v_xor_b32 v25, 4, v22
    v_lshlrev_b32 v25, 4, v25
    v_add_u32 v7, v24, v25
    v_subrev_u32 v7, 3072, v7
    v_add_u32 v24, s24, v20
    v_add_u32 v24, s30, v24
    v_add_u32 v24, 32, v24
    v_lshlrev_b32 v24, 10, v24
    v_mov_b32 v25, v22
    v_lshlrev_b32 v25, 4, v25
    v_add_u32 v8, v24, v25
    v_add_u32 v24, s24, v20
    v_add_u32 v24, s30, v24
    v_add_u32 v24, 40, v24
    v_lshlrev_b32 v24, 10, v24
    v_xor_b32 v25, 4, v22
    v_lshlrev_b32 v25, 4, v25
    v_add_u32 v9, v24, v25
    v_subrev_u32 v9, 1024, v9
    v_add_u32 v24, s24, v20
    v_add_u32 v24, s30, v24
    v_add_u32 v24, 48, v24
    v_lshlrev_b32 v24, 10, v24
    v_mov_b32 v25, v22
    v_lshlrev_b32 v25, 4, v25
    v_add_u32 v10, v24, v25
    v_subrev_u32 v10, 2048, v10
    v_add_u32 v24, s24, v20
    v_add_u32 v24, s30, v24
    v_add_u32 v24, 56, v24
    v_lshlrev_b32 v24, 10, v24
    v_xor_b32 v25, 4, v22
    v_lshlrev_b32 v25, 4, v25
    v_add_u32 v11, v24, v25
    v_subrev_u32 v11, 3072, v11
    v_add_u32 v24, s25, v20
    v_add_u32 v24, s31, v24
    v_lshlrev_b32 v24, 10, v24
    v_mov_b32 v25, v22
    v_lshlrev_b32 v25, 4, v25
    v_add_u32 v12, v24, v25
    v_add_u32 v24, s25, v20
    v_add_u32 v24, s31, v24
    v_add_u32 v24, 8, v24
    v_lshlrev_b32 v24, 10, v24
    v_xor_b32 v25, 4, v22
    v_lshlrev_b32 v25, 4, v25
    v_add_u32 v13, v24, v25
    v_subrev_u32 v13, 1024, v13
    v_add_u32 v24, s25, v20
    v_add_u32 v24, s31, v24
    v_add_u32 v24, 16, v24
    v_lshlrev_b32 v24, 10, v24
    v_mov_b32 v25, v22
    v_lshlrev_b32 v25, 4, v25
    v_add_u32 v14, v24, v25
    v_subrev_u32 v14, 2048, v14
    v_add_u32 v24, s25, v20
    v_add_u32 v24, s31, v24
    v_add_u32 v24, 24, v24
    v_lshlrev_b32 v24, 10, v24
    v_xor_b32 v25, 4, v22
    v_lshlrev_b32 v25, 4, v25
    v_add_u32 v15, v24, v25
    v_subrev_u32 v15, 3072, v15
    s_lshl_b32 s12, s17, 7
    s_mov_b32 s13, s12
    s_cmp_lt_u32 s17, s18
    s_cselect_b32 s6, s26, 0
    s_cselect_b32 s10, s27, 0
    s_add_u32 s17, s17, 1

    s_add_u32 m0, s14, 0
    s_nop 0
    buffer_load_dwordx4 v4, s[4:7], s12 offen offset:0 lds
    buffer_load_dwordx4 v5, s[4:7], s12 offen offset:1024 lds
    buffer_load_dwordx4 v6, s[4:7], s12 offen offset:2048 lds
    buffer_load_dwordx4 v7, s[4:7], s12 offen offset:3072 lds
    s_add_u32 m0, s14, 4096
    s_nop 0
    buffer_load_dwordx4 v8, s[4:7], s12 offen offset:0 lds
    buffer_load_dwordx4 v9, s[4:7], s12 offen offset:1024 lds
    buffer_load_dwordx4 v10, s[4:7], s12 offen offset:2048 lds
    buffer_load_dwordx4 v11, s[4:7], s12 offen offset:3072 lds
    s_add_u32 m0, s39, 98304
    s_nop 0
    buffer_load_dwordx4 v12, s[8:11], s13 offen offset:0 lds
    buffer_load_dwordx4 v13, s[8:11], s13 offen offset:1024 lds
    buffer_load_dwordx4 v14, s[8:11], s13 offen offset:2048 lds
    buffer_load_dwordx4 v15, s[8:11], s13 offen offset:3072 lds
    s_lshl_b32 s12, s17, 7
    s_mov_b32 s13, s12
    s_cmp_lt_u32 s17, s18
    s_cselect_b32 s6, s26, 0
    s_cselect_b32 s10, s27, 0
    s_add_u32 s17, s17, 1

    s_add_u32 m0, s14, 32768
    s_nop 0
    buffer_load_dwordx4 v4, s[4:7], s12 offen offset:0 lds
    buffer_load_dwordx4 v5, s[4:7], s12 offen offset:1024 lds
    buffer_load_dwordx4 v6, s[4:7], s12 offen offset:2048 lds
    buffer_load_dwordx4 v7, s[4:7], s12 offen offset:3072 lds
    s_add_u32 m0, s14, 36864
    s_nop 0
    buffer_load_dwordx4 v8, s[4:7], s12 offen offset:0 lds
    buffer_load_dwordx4 v9, s[4:7], s12 offen offset:1024 lds
    buffer_load_dwordx4 v10, s[4:7], s12 offen offset:2048 lds
    buffer_load_dwordx4 v11, s[4:7], s12 offen offset:3072 lds
    s_add_u32 m0, s39, 114688
    s_nop 0
    buffer_load_dwordx4 v12, s[8:11], s13 offen offset:0 lds
    buffer_load_dwordx4 v13, s[8:11], s13 offen offset:1024 lds
    buffer_load_dwordx4 v14, s[8:11], s13 offen offset:2048 lds
    buffer_load_dwordx4 v15, s[8:11], s13 offen offset:3072 lds
    s_waitcnt vmcnt(12)
    s_barrier

L_g1_lloop:
    s_cmp_ge_u32 s17, s18
    s_cbranch_scc1 L_g1_lskip0
    s_lshl_b32 s12, s17, 7
    s_mov_b32 s13, s12
    s_cmp_lt_u32 s17, s18
    s_cselect_b32 s6, s26, 0
    s_cselect_b32 s10, s27, 0
    s_add_u32 s17, s17, 1

    s_add_u32 m0, s14, 65536
    s_nop 0
    buffer_load_dwordx4 v4, s[4:7], s12 offen offset:0 lds
    buffer_load_dwordx4 v5, s[4:7], s12 offen offset:1024 lds
    buffer_load_dwordx4 v6, s[4:7], s12 offen offset:2048 lds
    buffer_load_dwordx4 v7, s[4:7], s12 offen offset:3072 lds
    s_add_u32 m0, s14, 69632
    s_nop 0
    buffer_load_dwordx4 v8, s[4:7], s12 offen offset:0 lds
    buffer_load_dwordx4 v9, s[4:7], s12 offen offset:1024 lds
    buffer_load_dwordx4 v10, s[4:7], s12 offen offset:2048 lds
    buffer_load_dwordx4 v11, s[4:7], s12 offen offset:3072 lds
    s_add_u32 m0, s39, 131072
    s_nop 0
    buffer_load_dwordx4 v12, s[8:11], s13 offen offset:0 lds
    buffer_load_dwordx4 v13, s[8:11], s13 offen offset:1024 lds
    buffer_load_dwordx4 v14, s[8:11], s13 offen offset:2048 lds
    buffer_load_dwordx4 v15, s[8:11], s13 offen offset:3072 lds
    s_waitcnt vmcnt(12)
    s_branch L_g1_lbar0
L_g1_lskip0:
    s_waitcnt vmcnt(0)
L_g1_lbar0:
    s_barrier
    s_add_u32 s15, s15, 1
    s_cmp_ge_u32 s15, s16
    s_cbranch_scc1 L_g1_ldone
    s_cmp_ge_u32 s17, s18
    s_cbranch_scc1 L_g1_lskip1
    s_lshl_b32 s12, s17, 7
    s_mov_b32 s13, s12
    s_cmp_lt_u32 s17, s18
    s_cselect_b32 s6, s26, 0
    s_cselect_b32 s10, s27, 0
    s_add_u32 s17, s17, 1

    s_add_u32 m0, s14, 0
    s_nop 0
    buffer_load_dwordx4 v4, s[4:7], s12 offen offset:0 lds
    buffer_load_dwordx4 v5, s[4:7], s12 offen offset:1024 lds
    buffer_load_dwordx4 v6, s[4:7], s12 offen offset:2048 lds
    buffer_load_dwordx4 v7, s[4:7], s12 offen offset:3072 lds
    s_add_u32 m0, s14, 4096
    s_nop 0
    buffer_load_dwordx4 v8, s[4:7], s12 offen offset:0 lds
    buffer_load_dwordx4 v9, s[4:7], s12 offen offset:1024 lds
    buffer_load_dwordx4 v10, s[4:7], s12 offen offset:2048 lds
    buffer_load_dwordx4 v11, s[4:7], s12 offen offset:3072 lds
    s_add_u32 m0, s39, 98304
    s_nop 0
    buffer_load_dwordx4 v12, s[8:11], s13 offen offset:0 lds
    buffer_load_dwordx4 v13, s[8:11], s13 offen offset:1024 lds
    buffer_load_dwordx4 v14, s[8:11], s13 offen offset:2048 lds
    buffer_load_dwordx4 v15, s[8:11], s13 offen offset:3072 lds
    s_waitcnt vmcnt(12)
    s_branch L_g1_lbar1
L_g1_lskip1:
    s_waitcnt vmcnt(0)
L_g1_lbar1:
    s_barrier
    s_add_u32 s15, s15, 1
    s_cmp_ge_u32 s15, s16
    s_cbranch_scc1 L_g1_ldone
    s_cmp_ge_u32 s17, s18
    s_cbranch_scc1 L_g1_lskip2
    s_lshl_b32 s12, s17, 7
    s_mov_b32 s13, s12
    s_cmp_lt_u32 s17, s18
    s_cselect_b32 s6, s26, 0
    s_cselect_b32 s10, s27, 0
    s_add_u32 s17, s17, 1

    s_add_u32 m0, s14, 32768
    s_nop 0
    buffer_load_dwordx4 v4, s[4:7], s12 offen offset:0 lds
    buffer_load_dwordx4 v5, s[4:7], s12 offen offset:1024 lds
    buffer_load_dwordx4 v6, s[4:7], s12 offen offset:2048 lds
    buffer_load_dwordx4 v7, s[4:7], s12 offen offset:3072 lds
    s_add_u32 m0, s14, 36864
    s_nop 0
    buffer_load_dwordx4 v8, s[4:7], s12 offen offset:0 lds
    buffer_load_dwordx4 v9, s[4:7], s12 offen offset:1024 lds
    buffer_load_dwordx4 v10, s[4:7], s12 offen offset:2048 lds
    buffer_load_dwordx4 v11, s[4:7], s12 offen offset:3072 lds
    s_add_u32 m0, s39, 114688
    s_nop 0
    buffer_load_dwordx4 v12, s[8:11], s13 offen offset:0 lds
    buffer_load_dwordx4 v13, s[8:11], s13 offen offset:1024 lds
    buffer_load_dwordx4 v14, s[8:11], s13 offen offset:2048 lds
    buffer_load_dwordx4 v15, s[8:11], s13 offen offset:3072 lds
    s_waitcnt vmcnt(12)
    s_branch L_g1_lbar2
L_g1_lskip2:
    s_waitcnt vmcnt(0)
L_g1_lbar2:
    s_barrier
    s_add_u32 s15, s15, 1
    s_cmp_ge_u32 s15, s16
    s_cbranch_scc0 L_g1_lloop
L_g1_ldone:
    s_endpgm
L_g1_compute:
    v_and_b32 v196, 31, v1
    v_lshrrev_b32 v197, 5, v1
    v_lshrrev_b32 v198, 1, v1
    v_and_b32 v198, 7, v198
    v_xor_b32 v198, v198, v197

    v_lshrrev_b32 v199, 1, v2
    v_mul_u32_u24 v199, 128, v199
    v_add_u32 v199, v199, v196
    v_lshlrev_b32 v199, 7, v199
    v_and_b32 v200, 1, v2
    v_lshlrev_b32 v200, 6, v200
    v_add_u32 v200, v200, v196
    v_lshlrev_b32 v200, 7, v200

    v_xor_b32 v201, 0, v198
    v_lshlrev_b32 v201, 4, v201
    v_add_u32 v180, v199, v201
    v_xor_b32 v201, 2, v198
    v_lshlrev_b32 v201, 4, v201
    v_add_u32 v181, v199, v201
    v_xor_b32 v201, 4, v198
    v_lshlrev_b32 v201, 4, v201
    v_add_u32 v182, v199, v201
    v_xor_b32 v201, 6, v198
    v_lshlrev_b32 v201, 4, v201
    v_add_u32 v183, v199, v201
    v_xor_b32 v201, 0, v198
    v_lshlrev_b32 v201, 4, v201
    v_add_u32 v184, v199, v201
    v_add_u32 v184, 65536, v184
    v_xor_b32 v201, 2, v198
    v_lshlrev_b32 v201, 4, v201
    v_add_u32 v185, v199, v201
    v_add_u32 v185, 65536, v185
    v_xor_b32 v201, 4, v198
    v_lshlrev_b32 v201, 4, v201
    v_add_u32 v186, v199, v201
    v_add_u32 v186, 65536, v186
    v_xor_b32 v201, 6, v198
    v_lshlrev_b32 v201, 4, v201
    v_add_u32 v187, v199, v201
    v_add_u32 v187, 65536, v187
    v_xor_b32 v201, 0, v198
    v_lshlrev_b32 v201, 4, v201
    v_add_u32 v188, v200, v201
    v_add_u32 v188, 65536, v188
    v_xor_b32 v201, 2, v198
    v_lshlrev_b32 v201, 4, v201
    v_add_u32 v189, v200, v201
    v_add_u32 v189, 65536, v189
    v_xor_b32 v201, 4, v198
    v_lshlrev_b32 v201, 4, v201
    v_add_u32 v190, v200, v201
    v_add_u32 v190, 65536, v190
    v_xor_b32 v201, 6, v198
    v_lshlrev_b32 v201, 4, v201
    v_add_u32 v191, v200, v201
    v_add_u32 v191, 65536, v191
    v_xor_b32 v201, 0, v198
    v_lshlrev_b32 v201, 4, v201
    v_add_u32 v192, v200, v201
    v_add_u32 v192, 131072, v192
    v_xor_b32 v201, 2, v198
    v_lshlrev_b32 v201, 4, v201
    v_add_u32 v193, v200, v201
    v_add_u32 v193, 131072, v193
    v_xor_b32 v201, 4, v198
    v_lshlrev_b32 v201, 4, v201
    v_add_u32 v194, v200, v201
    v_add_u32 v194, 131072, v194
    v_xor_b32 v201, 6, v198
    v_lshlrev_b32 v201, 4, v201
    v_add_u32 v195, v200, v201
    v_add_u32 v195, 131072, v195
    v_mov_b32 v52, 0
    v_mov_b32 v53, 0
    v_mov_b32 v54, 0
    v_mov_b32 v55, 0
    v_mov_b32 v56, 0
    v_mov_b32 v57, 0
    v_mov_b32 v58, 0
    v_mov_b32 v59, 0
    v_mov_b32 v60, 0
    v_mov_b32 v61, 0
    v_mov_b32 v62, 0
    v_mov_b32 v63, 0
    v_mov_b32 v64, 0
    v_mov_b32 v65, 0
    v_mov_b32 v66, 0
    v_mov_b32 v67, 0
    v_mov_b32 v68, 0
    v_mov_b32 v69, 0
    v_mov_b32 v70, 0
    v_mov_b32 v71, 0
    v_mov_b32 v72, 0
    v_mov_b32 v73, 0
    v_mov_b32 v74, 0
    v_mov_b32 v75, 0
    v_mov_b32 v76, 0
    v_mov_b32 v77, 0
    v_mov_b32 v78, 0
    v_mov_b32 v79, 0
    v_mov_b32 v80, 0
    v_mov_b32 v81, 0
    v_mov_b32 v82, 0
    v_mov_b32 v83, 0
    v_mov_b32 v84, 0
    v_mov_b32 v85, 0
    v_mov_b32 v86, 0
    v_mov_b32 v87, 0
    v_mov_b32 v88, 0
    v_mov_b32 v89, 0
    v_mov_b32 v90, 0
    v_mov_b32 v91, 0
    v_mov_b32 v92, 0
    v_mov_b32 v93, 0
    v_mov_b32 v94, 0
    v_mov_b32 v95, 0
    v_mov_b32 v96, 0
    v_mov_b32 v97, 0
    v_mov_b32 v98, 0
    v_mov_b32 v99, 0
    v_mov_b32 v100, 0
    v_mov_b32 v101, 0
    v_mov_b32 v102, 0
    v_mov_b32 v103, 0
    v_mov_b32 v104, 0
    v_mov_b32 v105, 0
    v_mov_b32 v106, 0
    v_mov_b32 v107, 0
    v_mov_b32 v108, 0
    v_mov_b32 v109, 0
    v_mov_b32 v110, 0
    v_mov_b32 v111, 0
    v_mov_b32 v112, 0
    v_mov_b32 v113, 0
    v_mov_b32 v114, 0
    v_mov_b32 v115, 0
    v_mov_b32 v116, 0
    v_mov_b32 v117, 0
    v_mov_b32 v118, 0
    v_mov_b32 v119, 0
    v_mov_b32 v120, 0
    v_mov_b32 v121, 0
    v_mov_b32 v122, 0
    v_mov_b32 v123, 0
    v_mov_b32 v124, 0
    v_mov_b32 v125, 0
    v_mov_b32 v126, 0
    v_mov_b32 v127, 0
    v_mov_b32 v128, 0
    v_mov_b32 v129, 0
    v_mov_b32 v130, 0
    v_mov_b32 v131, 0
    v_mov_b32 v132, 0
    v_mov_b32 v133, 0
    v_mov_b32 v134, 0
    v_mov_b32 v135, 0
    v_mov_b32 v136, 0
    v_mov_b32 v137, 0
    v_mov_b32 v138, 0
    v_mov_b32 v139, 0
    v_mov_b32 v140, 0
    v_mov_b32 v141, 0
    v_mov_b32 v142, 0
    v_mov_b32 v143, 0
    v_mov_b32 v144, 0
    v_mov_b32 v145, 0
    v_mov_b32 v146, 0
    v_mov_b32 v147, 0
    v_mov_b32 v148, 0
    v_mov_b32 v149, 0
    v_mov_b32 v150, 0
    v_mov_b32 v151, 0
    v_mov_b32 v152, 0
    v_mov_b32 v153, 0
    v_mov_b32 v154, 0
    v_mov_b32 v155, 0
    v_mov_b32 v156, 0
    v_mov_b32 v157, 0
    v_mov_b32 v158, 0
    v_mov_b32 v159, 0
    v_mov_b32 v160, 0
    v_mov_b32 v161, 0
    v_mov_b32 v162, 0
    v_mov_b32 v163, 0
    v_mov_b32 v164, 0
    v_mov_b32 v165, 0
    v_mov_b32 v166, 0
    v_mov_b32 v167, 0
    v_mov_b32 v168, 0
    v_mov_b32 v169, 0
    v_mov_b32 v170, 0
    v_mov_b32 v171, 0
    v_mov_b32 v172, 0
    v_mov_b32 v173, 0
    v_mov_b32 v174, 0
    v_mov_b32 v175, 0
    v_mov_b32 v176, 0
    v_mov_b32 v177, 0
    v_mov_b32 v178, 0
    v_mov_b32 v179, 0
    s_barrier
    ds_read_b128 v[4:7], v180 offset:0
    ds_read_b128 v[8:11], v180 offset:4096
    ds_read_b128 v[12:15], v180 offset:8192
    ds_read_b128 v[16:19], v180 offset:12288
    ds_read_b128 v[20:23], v188 offset:32768
    ds_read_b128 v[24:27], v188 offset:36864
L_g1_loop:
    ds_read_b128 v[28:31], v181 offset:0
    ds_read_b128 v[32:35], v181 offset:4096
    ds_read_b128 v[36:39], v181 offset:8192
    ds_read_b128 v[40:43], v181 offset:12288
    ds_read_b128 v[44:47], v189 offset:32768
    ds_read_b128 v[48:51], v189 offset:36864
    s_waitcnt lgkmcnt(6)
    v_mfma_f32_32x32x16_bf16 v[52:67], v[4:7], v[20:23], v[52:67]
    v_mfma_f32_32x32x16_bf16 v[68:83], v[4:7], v[24:27], v[68:83]
    v_mfma_f32_32x32x16_bf16 v[84:99], v[8:11], v[20:23], v[84:99]
    v_mfma_f32_32x32x16_bf16 v[100:115], v[8:11], v[24:27], v[100:115]
    v_mfma_f32_32x32x16_bf16 v[116:131], v[12:15], v[20:23], v[116:131]
    v_mfma_f32_32x32x16_bf16 v[132:147], v[12:15], v[24:27], v[132:147]
    v_mfma_f32_32x32x16_bf16 v[148:163], v[16:19], v[20:23], v[148:163]
    v_mfma_f32_32x32x16_bf16 v[164:179], v[16:19], v[24:27], v[164:179]
    ds_read_b128 v[4:7], v182 offset:0
    ds_read_b128 v[8:11], v182 offset:4096
    ds_read_b128 v[12:15], v182 offset:8192
    ds_read_b128 v[16:19], v182 offset:12288
    ds_read_b128 v[20:23], v190 offset:32768
    ds_read_b128 v[24:27], v190 offset:36864
    s_waitcnt lgkmcnt(6)
    v_mfma_f32_32x32x16_bf16 v[52:67], v[28:31], v[44:47], v[52:67]
    v_mfma_f32_32x32x16_bf16 v[68:83], v[28:31], v[48:51], v[68:83]
    v_mfma_f32_32x32x16_bf16 v[84:99], v[32:35], v[44:47], v[84:99]
    v_mfma_f32_32x32x16_bf16 v[100:115], v[32:35], v[48:51], v[100:115]
    v_mfma_f32_32x32x16_bf16 v[116:131], v[36:39], v[44:47], v[116:131]
    v_mfma_f32_32x32x16_bf16 v[132:147], v[36:39], v[48:51], v[132:147]
    v_mfma_f32_32x32x16_bf16 v[148:163], v[40:43], v[44:47], v[148:163]
    v_mfma_f32_32x32x16_bf16 v[164:179], v[40:43], v[48:51], v[164:179]
    ds_read_b128 v[28:31], v183 offset:0
    ds_read_b128 v[32:35], v183 offset:4096
    ds_read_b128 v[36:39], v183 offset:8192
    ds_read_b128 v[40:43], v183 offset:12288
    ds_read_b128 v[44:47], v191 offset:32768
    ds_read_b128 v[48:51], v191 offset:36864
    s_waitcnt lgkmcnt(6)
    v_mfma_f32_32x32x16_bf16 v[52:67], v[4:7], v[20:23], v[52:67]
    v_mfma_f32_32x32x16_bf16 v[68:83], v[4:7], v[24:27], v[68:83]
    v_mfma_f32_32x32x16_bf16 v[84:99], v[8:11], v[20:23], v[84:99]
    v_mfma_f32_32x32x16_bf16 v[100:115], v[8:11], v[24:27], v[100:115]
    v_mfma_f32_32x32x16_bf16 v[116:131], v[12:15], v[20:23], v[116:131]
    v_mfma_f32_32x32x16_bf16 v[132:147], v[12:15], v[24:27], v[132:147]
    v_mfma_f32_32x32x16_bf16 v[148:163], v[16:19], v[20:23], v[148:163]
    v_mfma_f32_32x32x16_bf16 v[164:179], v[16:19], v[24:27], v[164:179]
    s_waitcnt lgkmcnt(0)
    s_barrier
    ds_read_b128 v[4:7], v180 offset:32768
    ds_read_b128 v[8:11], v180 offset:36864
    ds_read_b128 v[12:15], v180 offset:40960
    ds_read_b128 v[16:19], v180 offset:45056
    ds_read_b128 v[20:23], v188 offset:49152
    ds_read_b128 v[24:27], v188 offset:53248
    v_mfma_f32_32x32x16_bf16 v[52:67], v[28:31], v[44:47], v[52:67]
    v_mfma_f32_32x32x16_bf16 v[68:83], v[28:31], v[48:51], v[68:83]
    v_mfma_f32_32x32x16_bf16 v[84:99], v[32:35], v[44:47], v[84:99]
    v_mfma_f32_32x32x16_bf16 v[100:115], v[32:35], v[48:51], v[100:115]
    v_mfma_f32_32x32x16_bf16 v[116:131], v[36:39], v[44:47], v[116:131]
    v_mfma_f32_32x32x16_bf16 v[132:147], v[36:39], v[48:51], v[132:147]
    v_mfma_f32_32x32x16_bf16 v[148:163], v[40:43], v[44:47], v[148:163]
    v_mfma_f32_32x32x16_bf16 v[164:179], v[40:43], v[48:51], v[164:179]
    s_add_u32 s15, s15, 1
    s_cmp_ge_u32 s15, s16
    s_cbranch_scc1 L_g1_done
    ds_read_b128 v[28:31], v181 offset:32768
    ds_read_b128 v[32:35], v181 offset:36864
    ds_read_b128 v[36:39], v181 offset:40960
    ds_read_b128 v[40:43], v181 offset:45056
    ds_read_b128 v[44:47], v189 offset:49152
    ds_read_b128 v[48:51], v189 offset:53248
    s_waitcnt lgkmcnt(6)
    v_mfma_f32_32x32x16_bf16 v[52:67], v[4:7], v[20:23], v[52:67]
    v_mfma_f32_32x32x16_bf16 v[68:83], v[4:7], v[24:27], v[68:83]
    v_mfma_f32_32x32x16_bf16 v[84:99], v[8:11], v[20:23], v[84:99]
    v_mfma_f32_32x32x16_bf16 v[100:115], v[8:11], v[24:27], v[100:115]
    v_mfma_f32_32x32x16_bf16 v[116:131], v[12:15], v[20:23], v[116:131]
    v_mfma_f32_32x32x16_bf16 v[132:147], v[12:15], v[24:27], v[132:147]
    v_mfma_f32_32x32x16_bf16 v[148:163], v[16:19], v[20:23], v[148:163]
    v_mfma_f32_32x32x16_bf16 v[164:179], v[16:19], v[24:27], v[164:179]
    ds_read_b128 v[4:7], v182 offset:32768
    ds_read_b128 v[8:11], v182 offset:36864
    ds_read_b128 v[12:15], v182 offset:40960
    ds_read_b128 v[16:19], v182 offset:45056
    ds_read_b128 v[20:23], v190 offset:49152
    ds_read_b128 v[24:27], v190 offset:53248
    s_waitcnt lgkmcnt(6)
    v_mfma_f32_32x32x16_bf16 v[52:67], v[28:31], v[44:47], v[52:67]
    v_mfma_f32_32x32x16_bf16 v[68:83], v[28:31], v[48:51], v[68:83]
    v_mfma_f32_32x32x16_bf16 v[84:99], v[32:35], v[44:47], v[84:99]
    v_mfma_f32_32x32x16_bf16 v[100:115], v[32:35], v[48:51], v[100:115]
    v_mfma_f32_32x32x16_bf16 v[116:131], v[36:39], v[44:47], v[116:131]
    v_mfma_f32_32x32x16_bf16 v[132:147], v[36:39], v[48:51], v[132:147]
    v_mfma_f32_32x32x16_bf16 v[148:163], v[40:43], v[44:47], v[148:163]
    v_mfma_f32_32x32x16_bf16 v[164:179], v[40:43], v[48:51], v[164:179]
    ds_read_b128 v[28:31], v183 offset:32768
    ds_read_b128 v[32:35], v183 offset:36864
    ds_read_b128 v[36:39], v183 offset:40960
    ds_read_b128 v[40:43], v183 offset:45056
    ds_read_b128 v[44:47], v191 offset:49152
    ds_read_b128 v[48:51], v191 offset:53248
    s_waitcnt lgkmcnt(6)
    v_mfma_f32_32x32x16_bf16 v[52:67], v[4:7], v[20:23], v[52:67]
    v_mfma_f32_32x32x16_bf16 v[68:83], v[4:7], v[24:27], v[68:83]
    v_mfma_f32_32x32x16_bf16 v[84:99], v[8:11], v[20:23], v[84:99]
    v_mfma_f32_32x32x16_bf16 v[100:115], v[8:11], v[24:27], v[100:115]
    v_mfma_f32_32x32x16_bf16 v[116:131], v[12:15], v[20:23], v[116:131]
    v_mfma_f32_32x32x16_bf16 v[132:147], v[12:15], v[24:27], v[132:147]
    v_mfma_f32_32x32x16_bf16 v[148:163], v[16:19], v[20:23], v[148:163]
    v_mfma_f32_32x32x16_bf16 v[164:179], v[16:19], v[24:27], v[164:179]
    s_waitcnt lgkmcnt(0)
    s_barrier
    ds_read_b128 v[4:7], v184 offset:0
    ds_read_b128 v[8:11], v184 offset:4096
    ds_read_b128 v[12:15], v184 offset:8192
    ds_read_b128 v[16:19], v184 offset:12288
    ds_read_b128 v[20:23], v192 offset:0
    ds_read_b128 v[24:27], v192 offset:4096
    v_mfma_f32_32x32x16_bf16 v[52:67], v[28:31], v[44:47], v[52:67]
    v_mfma_f32_32x32x16_bf16 v[68:83], v[28:31], v[48:51], v[68:83]
    v_mfma_f32_32x32x16_bf16 v[84:99], v[32:35], v[44:47], v[84:99]
    v_mfma_f32_32x32x16_bf16 v[100:115], v[32:35], v[48:51], v[100:115]
    v_mfma_f32_32x32x16_bf16 v[116:131], v[36:39], v[44:47], v[116:131]
    v_mfma_f32_32x32x16_bf16 v[132:147], v[36:39], v[48:51], v[132:147]
    v_mfma_f32_32x32x16_bf16 v[148:163], v[40:43], v[44:47], v[148:163]
    v_mfma_f32_32x32x16_bf16 v[164:179], v[40:43], v[48:51], v[164:179]
    s_add_u32 s15, s15, 1
    s_cmp_ge_u32 s15, s16
    s_cbranch_scc1 L_g1_done
    ds_read_b128 v[28:31], v185 offset:0
    ds_read_b128 v[32:35], v185 offset:4096
    ds_read_b128 v[36:39], v185 offset:8192
    ds_read_b128 v[40:43], v185 offset:12288
    ds_read_b128 v[44:47], v193 offset:0
    ds_read_b128 v[48:51], v193 offset:4096
    s_waitcnt lgkmcnt(6)
    v_mfma_f32_32x32x16_bf16 v[52:67], v[4:7], v[20:23], v[52:67]
    v_mfma_f32_32x32x16_bf16 v[68:83], v[4:7], v[24:27], v[68:83]
    v_mfma_f32_32x32x16_bf16 v[84:99], v[8:11], v[20:23], v[84:99]
    v_mfma_f32_32x32x16_bf16 v[100:115], v[8:11], v[24:27], v[100:115]
    v_mfma_f32_32x32x16_bf16 v[116:131], v[12:15], v[20:23], v[116:131]
    v_mfma_f32_32x32x16_bf16 v[132:147], v[12:15], v[24:27], v[132:147]
    v_mfma_f32_32x32x16_bf16 v[148:163], v[16:19], v[20:23], v[148:163]
    v_mfma_f32_32x32x16_bf16 v[164:179], v[16:19], v[24:27], v[164:179]
    ds_read_b128 v[4:7], v186 offset:0
    ds_read_b128 v[8:11], v186 offset:4096
    ds_read_b128 v[12:15], v186 offset:8192
    ds_read_b128 v[16:19], v186 offset:12288
    ds_read_b128 v[20:23], v194 offset:0
    ds_read_b128 v[24:27], v194 offset:4096
    s_waitcnt lgkmcnt(6)
    v_mfma_f32_32x32x16_bf16 v[52:67], v[28:31], v[44:47], v[52:67]
    v_mfma_f32_32x32x16_bf16 v[68:83], v[28:31], v[48:51], v[68:83]
    v_mfma_f32_32x32x16_bf16 v[84:99], v[32:35], v[44:47], v[84:99]
    v_mfma_f32_32x32x16_bf16 v[100:115], v[32:35], v[48:51], v[100:115]
    v_mfma_f32_32x32x16_bf16 v[116:131], v[36:39], v[44:47], v[116:131]
    v_mfma_f32_32x32x16_bf16 v[132:147], v[36:39], v[48:51], v[132:147]
    v_mfma_f32_32x32x16_bf16 v[148:163], v[40:43], v[44:47], v[148:163]
    v_mfma_f32_32x32x16_bf16 v[164:179], v[40:43], v[48:51], v[164:179]
    ds_read_b128 v[28:31], v187 offset:0
    ds_read_b128 v[32:35], v187 offset:4096
    ds_read_b128 v[36:39], v187 offset:8192
    ds_read_b128 v[40:43], v187 offset:12288
    ds_read_b128 v[44:47], v195 offset:0
    ds_read_b128 v[48:51], v195 offset:4096
    s_waitcnt lgkmcnt(6)
    v_mfma_f32_32x32x16_bf16 v[52:67], v[4:7], v[20:23], v[52:67]
    v_mfma_f32_32x32x16_bf16 v[68:83], v[4:7], v[24:27], v[68:83]
    v_mfma_f32_32x32x16_bf16 v[84:99], v[8:11], v[20:23], v[84:99]
    v_mfma_f32_32x32x16_bf16 v[100:115], v[8:11], v[24:27], v[100:115]
    v_mfma_f32_32x32x16_bf16 v[116:131], v[12:15], v[20:23], v[116:131]
    v_mfma_f32_32x32x16_bf16 v[132:147], v[12:15], v[24:27], v[132:147]
    v_mfma_f32_32x32x16_bf16 v[148:163], v[16:19], v[20:23], v[148:163]
    v_mfma_f32_32x32x16_bf16 v[164:179], v[16:19], v[24:27], v[164:179]
    s_waitcnt lgkmcnt(0)
    s_barrier
    ds_read_b128 v[4:7], v180 offset:0
    ds_read_b128 v[8:11], v180 offset:4096
    ds_read_b128 v[12:15], v180 offset:8192
    ds_read_b128 v[16:19], v180 offset:12288
    ds_read_b128 v[20:23], v188 offset:32768
    ds_read_b128 v[24:27], v188 offset:36864
    v_mfma_f32_32x32x16_bf16 v[52:67], v[28:31], v[44:47], v[52:67]
    v_mfma_f32_32x32x16_bf16 v[68:83], v[28:31], v[48:51], v[68:83]
    v_mfma_f32_32x32x16_bf16 v[84:99], v[32:35], v[44:47], v[84:99]
    v_mfma_f32_32x32x16_bf16 v[100:115], v[32:35], v[48:51], v[100:115]
    v_mfma_f32_32x32x16_bf16 v[116:131], v[36:39], v[44:47], v[116:131]
    v_mfma_f32_32x32x16_bf16 v[132:147], v[36:39], v[48:51], v[132:147]
    v_mfma_f32_32x32x16_bf16 v[148:163], v[40:43], v[44:47], v[148:163]
    v_mfma_f32_32x32x16_bf16 v[164:179], v[40:43], v[48:51], v[164:179]
    s_add_u32 s15, s15, 1
    s_cmp_ge_u32 s15, s16
    s_cbranch_scc0 L_g1_loop
L_g1_done:
    s_waitcnt lgkmcnt(0)
    s_nop 15
    v_and_b32 v196, 31, v1
    v_lshrrev_b32 v197, 5, v1
    s_lshr_b32 s28, s19, 1
    s_and_b32 s29, s19, 1
    s_cmp_ge_u32 s21, 8
    s_cbranch_scc1 L_g1_epi_ffn

    s_lshr_b32 s30, s21, 2
    s_lshl_b32 s30, s30, 21
    s_add_u32 s30, s30, 8388608
    s_add_u32 s32, s44, s30
    s_addc_u32 s33, s45, 0
    s_mov_b32 s34, 2097152
    s_mov_b32 s35, 0x00020000
    s_mul_i32 s36, s19, 17408
    v_mul_u32_u24 v198, 272, v196
    v_lshlrev_b32 v199, 3, v197
    v_add3_u32 v198, v198, v199, s36
    s_cmp_ge_u32 s21, 4
    s_cselect_b32 s31, 0x80008000, 0
    s_barrier

    v_cvt_pk_bf16_f32 v200, v52, v53
    v_cvt_pk_bf16_f32 v201, v54, v55
    v_xor_b32 v200, s31, v200
    v_xor_b32 v201, s31, v201
    ds_write_b64 v198, v[200:201] offset:0
    v_cvt_pk_bf16_f32 v202, v56, v57
    v_cvt_pk_bf16_f32 v203, v58, v59
    v_xor_b32 v202, s31, v202
    v_xor_b32 v203, s31, v203
    ds_write_b64 v198, v[202:203] offset:16
    v_cvt_pk_bf16_f32 v204, v60, v61
    v_cvt_pk_bf16_f32 v205, v62, v63
    v_xor_b32 v204, s31, v204
    v_xor_b32 v205, s31, v205
    ds_write_b64 v198, v[204:205] offset:32
    v_cvt_pk_bf16_f32 v206, v64, v65
    v_cvt_pk_bf16_f32 v207, v66, v67
    v_xor_b32 v206, s31, v206
    v_xor_b32 v207, s31, v207
    ds_write_b64 v198, v[206:207] offset:48
    v_cvt_pk_bf16_f32 v200, v68, v69
    v_cvt_pk_bf16_f32 v201, v70, v71
    v_xor_b32 v200, s31, v200
    v_xor_b32 v201, s31, v201
    ds_write_b64 v198, v[200:201] offset:8704
    v_cvt_pk_bf16_f32 v202, v72, v73
    v_cvt_pk_bf16_f32 v203, v74, v75
    v_xor_b32 v202, s31, v202
    v_xor_b32 v203, s31, v203
    ds_write_b64 v198, v[202:203] offset:8720
    v_cvt_pk_bf16_f32 v204, v76, v77
    v_cvt_pk_bf16_f32 v205, v78, v79
    v_xor_b32 v204, s31, v204
    v_xor_b32 v205, s31, v205
    ds_write_b64 v198, v[204:205] offset:8736
    v_cvt_pk_bf16_f32 v206, v80, v81
    v_cvt_pk_bf16_f32 v207, v82, v83
    v_xor_b32 v206, s31, v206
    v_xor_b32 v207, s31, v207
    ds_write_b64 v198, v[206:207] offset:8752
    v_cvt_pk_bf16_f32 v200, v84, v85
    v_cvt_pk_bf16_f32 v201, v86, v87
    v_xor_b32 v200, s31, v200
    v_xor_b32 v201, s31, v201
    ds_write_b64 v198, v[200:201] offset:64
    v_cvt_pk_bf16_f32 v202, v88, v89
    v_cvt_pk_bf16_f32 v203, v90, v91
    v_xor_b32 v202, s31, v202
    v_xor_b32 v203, s31, v203
    ds_write_b64 v198, v[202:203] offset:80
    v_cvt_pk_bf16_f32 v204, v92, v93
    v_cvt_pk_bf16_f32 v205, v94, v95
    v_xor_b32 v204, s31, v204
    v_xor_b32 v205, s31, v205
    ds_write_b64 v198, v[204:205] offset:96
    v_cvt_pk_bf16_f32 v206, v96, v97
    v_cvt_pk_bf16_f32 v207, v98, v99
    v_xor_b32 v206, s31, v206
    v_xor_b32 v207, s31, v207
    ds_write_b64 v198, v[206:207] offset:112
    v_cvt_pk_bf16_f32 v200, v100, v101
    v_cvt_pk_bf16_f32 v201, v102, v103
    v_xor_b32 v200, s31, v200
    v_xor_b32 v201, s31, v201
    ds_write_b64 v198, v[200:201] offset:8768
    v_cvt_pk_bf16_f32 v202, v104, v105
    v_cvt_pk_bf16_f32 v203, v106, v107
    v_xor_b32 v202, s31, v202
    v_xor_b32 v203, s31, v203
    ds_write_b64 v198, v[202:203] offset:8784
    v_cvt_pk_bf16_f32 v204, v108, v109
    v_cvt_pk_bf16_f32 v205, v110, v111
    v_xor_b32 v204, s31, v204
    v_xor_b32 v205, s31, v205
    ds_write_b64 v198, v[204:205] offset:8800
    v_cvt_pk_bf16_f32 v206, v112, v113
    v_cvt_pk_bf16_f32 v207, v114, v115
    v_xor_b32 v206, s31, v206
    v_xor_b32 v207, s31, v207
    ds_write_b64 v198, v[206:207] offset:8816
    v_cvt_pk_bf16_f32 v200, v116, v117
    v_cvt_pk_bf16_f32 v201, v118, v119
    v_xor_b32 v200, s31, v200
    v_xor_b32 v201, s31, v201
    ds_write_b64 v198, v[200:201] offset:128
    v_cvt_pk_bf16_f32 v202, v120, v121
    v_cvt_pk_bf16_f32 v203, v122, v123
    v_xor_b32 v202, s31, v202
    v_xor_b32 v203, s31, v203
    ds_write_b64 v198, v[202:203] offset:144
    v_cvt_pk_bf16_f32 v204, v124, v125
    v_cvt_pk_bf16_f32 v205, v126, v127
    v_xor_b32 v204, s31, v204
    v_xor_b32 v205, s31, v205
    ds_write_b64 v198, v[204:205] offset:160
    v_cvt_pk_bf16_f32 v206, v128, v129
    v_cvt_pk_bf16_f32 v207, v130, v131
    v_xor_b32 v206, s31, v206
    v_xor_b32 v207, s31, v207
    ds_write_b64 v198, v[206:207] offset:176
    v_cvt_pk_bf16_f32 v200, v132, v133
    v_cvt_pk_bf16_f32 v201, v134, v135
    v_xor_b32 v200, s31, v200
    v_xor_b32 v201, s31, v201
    ds_write_b64 v198, v[200:201] offset:8832
    v_cvt_pk_bf16_f32 v202, v136, v137
    v_cvt_pk_bf16_f32 v203, v138, v139
    v_xor_b32 v202, s31, v202
    v_xor_b32 v203, s31, v203
    ds_write_b64 v198, v[202:203] offset:8848
    v_cvt_pk_bf16_f32 v204, v140, v141
    v_cvt_pk_bf16_f32 v205, v142, v143
    v_xor_b32 v204, s31, v204
    v_xor_b32 v205, s31, v205
    ds_write_b64 v198, v[204:205] offset:8864
    v_cvt_pk_bf16_f32 v206, v144, v145
    v_cvt_pk_bf16_f32 v207, v146, v147
    v_xor_b32 v206, s31, v206
    v_xor_b32 v207, s31, v207
    ds_write_b64 v198, v[206:207] offset:8880
    v_cvt_pk_bf16_f32 v200, v148, v149
    v_cvt_pk_bf16_f32 v201, v150, v151
    v_xor_b32 v200, s31, v200
    v_xor_b32 v201, s31, v201
    ds_write_b64 v198, v[200:201] offset:192
    v_cvt_pk_bf16_f32 v202, v152, v153
    v_cvt_pk_bf16_f32 v203, v154, v155
    v_xor_b32 v202, s31, v202
    v_xor_b32 v203, s31, v203
    ds_write_b64 v198, v[202:203] offset:208
    v_cvt_pk_bf16_f32 v204, v156, v157
    v_cvt_pk_bf16_f32 v205, v158, v159
    v_xor_b32 v204, s31, v204
    v_xor_b32 v205, s31, v205
    ds_write_b64 v198, v[204:205] offset:224
    v_cvt_pk_bf16_f32 v206, v160, v161
    v_cvt_pk_bf16_f32 v207, v162, v163
    v_xor_b32 v206, s31, v206
    v_xor_b32 v207, s31, v207
    ds_write_b64 v198, v[206:207] offset:240
    v_cvt_pk_bf16_f32 v200, v164, v165
    v_cvt_pk_bf16_f32 v201, v166, v167
    v_xor_b32 v200, s31, v200
    v_xor_b32 v201, s31, v201
    ds_write_b64 v198, v[200:201] offset:8896
    v_cvt_pk_bf16_f32 v202, v168, v169
    v_cvt_pk_bf16_f32 v203, v170, v171
    v_xor_b32 v202, s31, v202
    v_xor_b32 v203, s31, v203
    ds_write_b64 v198, v[202:203] offset:8912
    v_cvt_pk_bf16_f32 v204, v172, v173
    v_cvt_pk_bf16_f32 v205, v174, v175
    v_xor_b32 v204, s31, v204
    v_xor_b32 v205, s31, v205
    ds_write_b64 v198, v[204:205] offset:8928
    v_cvt_pk_bf16_f32 v206, v176, v177
    v_cvt_pk_bf16_f32 v207, v178, v179
    v_xor_b32 v206, s31, v206
    v_xor_b32 v207, s31, v207
    ds_write_b64 v198, v[206:207] offset:8944
    v_lshrrev_b32 v199, 4, v1
    v_and_b32 v200, 15, v1
    v_lshlrev_b32 v200, 4, v200
    v_mul_u32_u24 v201, 272, v199
    v_add3_u32 v201, v201, v200, s36
    v_lshlrev_b32 v199, 12, v199
    v_add_u32 v199, v199, v200
    s_lshl_b32 s30, s29, 6
    s_add_u32 s30, s30, s25
    s_lshl_b32 s30, s30, 12
    s_lshl_b32 s37, s28, 7
    s_add_u32 s37, s37, s24
    s_lshl_b32 s37, s37, 1
    s_add_u32 s30, s30, s37
    s_waitcnt lgkmcnt(0)

    ds_read_b128 v[52:55], v201 offset:0
    ds_read_b128 v[56:59], v201 offset:1088
    ds_read_b128 v[60:63], v201 offset:2176
    ds_read_b128 v[64:67], v201 offset:3264
    ds_read_b128 v[68:71], v201 offset:4352
    ds_read_b128 v[72:75], v201 offset:5440
    ds_read_b128 v[76:79], v201 offset:6528
    ds_read_b128 v[80:83], v201 offset:7616
    ds_read_b128 v[84:87], v201 offset:8704
    ds_read_b128 v[88:91], v201 offset:9792
    ds_read_b128 v[92:95], v201 offset:10880
    ds_read_b128 v[96:99], v201 offset:11968
    ds_read_b128 v[100:103], v201 offset:13056
    ds_read_b128 v[104:107], v201 offset:14144
    ds_read_b128 v[108:111], v201 offset:15232
    ds_read_b128 v[112:115], v201 offset:16320
    s_waitcnt lgkmcnt(15)
    buffer_store_dwordx4 v[52:55], v199, s[32:35], s30 offen
    s_add_u32 s30, s30, 0x4000
    s_waitcnt lgkmcnt(14)
    buffer_store_dwordx4 v[56:59], v199, s[32:35], s30 offen
    s_add_u32 s30, s30, 0x4000
    s_waitcnt lgkmcnt(13)
    buffer_store_dwordx4 v[60:63], v199, s[32:35], s30 offen
    s_add_u32 s30, s30, 0x4000
    s_waitcnt lgkmcnt(12)
    buffer_store_dwordx4 v[64:67], v199, s[32:35], s30 offen
    s_add_u32 s30, s30, 0x4000
    s_waitcnt lgkmcnt(11)
    buffer_store_dwordx4 v[68:71], v199, s[32:35], s30 offen
    s_add_u32 s30, s30, 0x4000
    s_waitcnt lgkmcnt(10)
    buffer_store_dwordx4 v[72:75], v199, s[32:35], s30 offen
    s_add_u32 s30, s30, 0x4000
    s_waitcnt lgkmcnt(9)
    buffer_store_dwordx4 v[76:79], v199, s[32:35], s30 offen
    s_add_u32 s30, s30, 0x4000
    s_waitcnt lgkmcnt(8)
    buffer_store_dwordx4 v[80:83], v199, s[32:35], s30 offen
    s_add_u32 s30, s30, 0x4000
    s_waitcnt lgkmcnt(7)
    buffer_store_dwordx4 v[84:87], v199, s[32:35], s30 offen
    s_add_u32 s30, s30, 0x4000
    s_waitcnt lgkmcnt(6)
    buffer_store_dwordx4 v[88:91], v199, s[32:35], s30 offen
    s_add_u32 s30, s30, 0x4000
    s_waitcnt lgkmcnt(5)
    buffer_store_dwordx4 v[92:95], v199, s[32:35], s30 offen
    s_add_u32 s30, s30, 0x4000
    s_waitcnt lgkmcnt(4)
    buffer_store_dwordx4 v[96:99], v199, s[32:35], s30 offen
    s_add_u32 s30, s30, 0x4000
    s_waitcnt lgkmcnt(3)
    buffer_store_dwordx4 v[100:103], v199, s[32:35], s30 offen
    s_add_u32 s30, s30, 0x4000
    s_waitcnt lgkmcnt(2)
    buffer_store_dwordx4 v[104:107], v199, s[32:35], s30 offen
    s_add_u32 s30, s30, 0x4000
    s_waitcnt lgkmcnt(1)
    buffer_store_dwordx4 v[108:111], v199, s[32:35], s30 offen
    s_add_u32 s30, s30, 0x4000
    s_waitcnt lgkmcnt(0)
    buffer_store_dwordx4 v[112:115], v199, s[32:35], s30 offen
    s_add_u32 s30, s30, 0x4000
    s_endpgm
L_g1_epi_ffn:
    s_add_u32 s32, s44, 16777216
    s_addc_u32 s33, s45, 0
    s_mov_b32 s34, 8388608
    s_mov_b32 s35, 0x00020000
    s_mul_i32 s36, s19, 9216
    v_mul_u32_u24 v198, 144, v196
    v_lshlrev_b32 v199, 3, v197
    v_add3_u32 v198, v198, v199, s36
    v_mov_b32 v200, 0xc0135761
    v_mov_b32 v201, 0xc0135761
    v_mov_b32 v206, 0xbdd2d3e8
    v_mov_b32 v207, 0xbdd2d3e8
    s_barrier

    v_pk_mul_f32 v[4:5], v[52:53], v[52:53]
    v_pk_mul_f32 v[6:7], v[54:55], v[54:55]
    v_pk_fma_f32 v[4:5], v[4:5], v[206:207], v[200:201]
    v_pk_fma_f32 v[6:7], v[6:7], v[206:207], v[200:201]
    v_pk_mul_f32 v[4:5], v[4:5], v[52:53]
    v_pk_mul_f32 v[6:7], v[6:7], v[54:55]
    v_exp_f32 v4, v4
    v_exp_f32 v5, v5
    v_exp_f32 v6, v6
    v_exp_f32 v7, v7
    v_pk_mul_f32 v[8:9], v[52:53], v[84:85]
    v_pk_mul_f32 v[10:11], v[54:55], v[86:87]
    v_pk_add_f32 v[4:5], v[4:5], 1.0 op_sel_hi:[1,0]
    v_pk_add_f32 v[6:7], v[6:7], 1.0 op_sel_hi:[1,0]
    v_rcp_f32 v4, v4
    v_rcp_f32 v5, v5
    v_rcp_f32 v6, v6
    v_rcp_f32 v7, v7
    s_nop 0
    v_pk_mul_f32 v[4:5], v[4:5], v[8:9]
    v_pk_mul_f32 v[6:7], v[6:7], v[10:11]
    v_cvt_pk_bf16_f32 v202, v4, v5
    v_cvt_pk_bf16_f32 v203, v6, v7
    ds_write_b64 v198, v[202:203] offset:0
    v_pk_mul_f32 v[12:13], v[56:57], v[56:57]
    v_pk_mul_f32 v[14:15], v[58:59], v[58:59]
    v_pk_fma_f32 v[12:13], v[12:13], v[206:207], v[200:201]
    v_pk_fma_f32 v[14:15], v[14:15], v[206:207], v[200:201]
    v_pk_mul_f32 v[12:13], v[12:13], v[56:57]
    v_pk_mul_f32 v[14:15], v[14:15], v[58:59]
    v_exp_f32 v12, v12
    v_exp_f32 v13, v13
    v_exp_f32 v14, v14
    v_exp_f32 v15, v15
    v_pk_mul_f32 v[16:17], v[56:57], v[88:89]
    v_pk_mul_f32 v[18:19], v[58:59], v[90:91]
    v_pk_add_f32 v[12:13], v[12:13], 1.0 op_sel_hi:[1,0]
    v_pk_add_f32 v[14:15], v[14:15], 1.0 op_sel_hi:[1,0]
    v_rcp_f32 v12, v12
    v_rcp_f32 v13, v13
    v_rcp_f32 v14, v14
    v_rcp_f32 v15, v15
    s_nop 0
    v_pk_mul_f32 v[12:13], v[12:13], v[16:17]
    v_pk_mul_f32 v[14:15], v[14:15], v[18:19]
    v_cvt_pk_bf16_f32 v204, v12, v13
    v_cvt_pk_bf16_f32 v205, v14, v15
    ds_write_b64 v198, v[204:205] offset:16
    v_pk_mul_f32 v[4:5], v[60:61], v[60:61]
    v_pk_mul_f32 v[6:7], v[62:63], v[62:63]
    v_pk_fma_f32 v[4:5], v[4:5], v[206:207], v[200:201]
    v_pk_fma_f32 v[6:7], v[6:7], v[206:207], v[200:201]
    v_pk_mul_f32 v[4:5], v[4:5], v[60:61]
    v_pk_mul_f32 v[6:7], v[6:7], v[62:63]
    v_exp_f32 v4, v4
    v_exp_f32 v5, v5
    v_exp_f32 v6, v6
    v_exp_f32 v7, v7
    v_pk_mul_f32 v[8:9], v[60:61], v[92:93]
    v_pk_mul_f32 v[10:11], v[62:63], v[94:95]
    v_pk_add_f32 v[4:5], v[4:5], 1.0 op_sel_hi:[1,0]
    v_pk_add_f32 v[6:7], v[6:7], 1.0 op_sel_hi:[1,0]
    v_rcp_f32 v4, v4
    v_rcp_f32 v5, v5
    v_rcp_f32 v6, v6
    v_rcp_f32 v7, v7
    s_nop 0
    v_pk_mul_f32 v[4:5], v[4:5], v[8:9]
    v_pk_mul_f32 v[6:7], v[6:7], v[10:11]
    v_cvt_pk_bf16_f32 v202, v4, v5
    v_cvt_pk_bf16_f32 v203, v6, v7
    ds_write_b64 v198, v[202:203] offset:32
    v_pk_mul_f32 v[12:13], v[64:65], v[64:65]
    v_pk_mul_f32 v[14:15], v[66:67], v[66:67]
    v_pk_fma_f32 v[12:13], v[12:13], v[206:207], v[200:201]
    v_pk_fma_f32 v[14:15], v[14:15], v[206:207], v[200:201]
    v_pk_mul_f32 v[12:13], v[12:13], v[64:65]
    v_pk_mul_f32 v[14:15], v[14:15], v[66:67]
    v_exp_f32 v12, v12
    v_exp_f32 v13, v13
    v_exp_f32 v14, v14
    v_exp_f32 v15, v15
    v_pk_mul_f32 v[16:17], v[64:65], v[96:97]
    v_pk_mul_f32 v[18:19], v[66:67], v[98:99]
    v_pk_add_f32 v[12:13], v[12:13], 1.0 op_sel_hi:[1,0]
    v_pk_add_f32 v[14:15], v[14:15], 1.0 op_sel_hi:[1,0]
    v_rcp_f32 v12, v12
    v_rcp_f32 v13, v13
    v_rcp_f32 v14, v14
    v_rcp_f32 v15, v15
    s_nop 0
    v_pk_mul_f32 v[12:13], v[12:13], v[16:17]
    v_pk_mul_f32 v[14:15], v[14:15], v[18:19]
    v_cvt_pk_bf16_f32 v204, v12, v13
    v_cvt_pk_bf16_f32 v205, v14, v15
    ds_write_b64 v198, v[204:205] offset:48
    v_pk_mul_f32 v[4:5], v[68:69], v[68:69]
    v_pk_mul_f32 v[6:7], v[70:71], v[70:71]
    v_pk_fma_f32 v[4:5], v[4:5], v[206:207], v[200:201]
    v_pk_fma_f32 v[6:7], v[6:7], v[206:207], v[200:201]
    v_pk_mul_f32 v[4:5], v[4:5], v[68:69]
    v_pk_mul_f32 v[6:7], v[6:7], v[70:71]
    v_exp_f32 v4, v4
    v_exp_f32 v5, v5
    v_exp_f32 v6, v6
    v_exp_f32 v7, v7
    v_pk_mul_f32 v[8:9], v[68:69], v[100:101]
    v_pk_mul_f32 v[10:11], v[70:71], v[102:103]
    v_pk_add_f32 v[4:5], v[4:5], 1.0 op_sel_hi:[1,0]
    v_pk_add_f32 v[6:7], v[6:7], 1.0 op_sel_hi:[1,0]
    v_rcp_f32 v4, v4
    v_rcp_f32 v5, v5
    v_rcp_f32 v6, v6
    v_rcp_f32 v7, v7
    s_nop 0
    v_pk_mul_f32 v[4:5], v[4:5], v[8:9]
    v_pk_mul_f32 v[6:7], v[6:7], v[10:11]
    v_cvt_pk_bf16_f32 v202, v4, v5
    v_cvt_pk_bf16_f32 v203, v6, v7
    ds_write_b64 v198, v[202:203] offset:4608
    v_pk_mul_f32 v[12:13], v[72:73], v[72:73]
    v_pk_mul_f32 v[14:15], v[74:75], v[74:75]
    v_pk_fma_f32 v[12:13], v[12:13], v[206:207], v[200:201]
    v_pk_fma_f32 v[14:15], v[14:15], v[206:207], v[200:201]
    v_pk_mul_f32 v[12:13], v[12:13], v[72:73]
    v_pk_mul_f32 v[14:15], v[14:15], v[74:75]
    v_exp_f32 v12, v12
    v_exp_f32 v13, v13
    v_exp_f32 v14, v14
    v_exp_f32 v15, v15
    v_pk_mul_f32 v[16:17], v[72:73], v[104:105]
    v_pk_mul_f32 v[18:19], v[74:75], v[106:107]
    v_pk_add_f32 v[12:13], v[12:13], 1.0 op_sel_hi:[1,0]
    v_pk_add_f32 v[14:15], v[14:15], 1.0 op_sel_hi:[1,0]
    v_rcp_f32 v12, v12
    v_rcp_f32 v13, v13
    v_rcp_f32 v14, v14
    v_rcp_f32 v15, v15
    s_nop 0
    v_pk_mul_f32 v[12:13], v[12:13], v[16:17]
    v_pk_mul_f32 v[14:15], v[14:15], v[18:19]
    v_cvt_pk_bf16_f32 v204, v12, v13
    v_cvt_pk_bf16_f32 v205, v14, v15
    ds_write_b64 v198, v[204:205] offset:4624
    v_pk_mul_f32 v[4:5], v[76:77], v[76:77]
    v_pk_mul_f32 v[6:7], v[78:79], v[78:79]
    v_pk_fma_f32 v[4:5], v[4:5], v[206:207], v[200:201]
    v_pk_fma_f32 v[6:7], v[6:7], v[206:207], v[200:201]
    v_pk_mul_f32 v[4:5], v[4:5], v[76:77]
    v_pk_mul_f32 v[6:7], v[6:7], v[78:79]
    v_exp_f32 v4, v4
    v_exp_f32 v5, v5
    v_exp_f32 v6, v6
    v_exp_f32 v7, v7
    v_pk_mul_f32 v[8:9], v[76:77], v[108:109]
    v_pk_mul_f32 v[10:11], v[78:79], v[110:111]
    v_pk_add_f32 v[4:5], v[4:5], 1.0 op_sel_hi:[1,0]
    v_pk_add_f32 v[6:7], v[6:7], 1.0 op_sel_hi:[1,0]
    v_rcp_f32 v4, v4
    v_rcp_f32 v5, v5
    v_rcp_f32 v6, v6
    v_rcp_f32 v7, v7
    s_nop 0
    v_pk_mul_f32 v[4:5], v[4:5], v[8:9]
    v_pk_mul_f32 v[6:7], v[6:7], v[10:11]
    v_cvt_pk_bf16_f32 v202, v4, v5
    v_cvt_pk_bf16_f32 v203, v6, v7
    ds_write_b64 v198, v[202:203] offset:4640
    v_pk_mul_f32 v[12:13], v[80:81], v[80:81]
    v_pk_mul_f32 v[14:15], v[82:83], v[82:83]
    v_pk_fma_f32 v[12:13], v[12:13], v[206:207], v[200:201]
    v_pk_fma_f32 v[14:15], v[14:15], v[206:207], v[200:201]
    v_pk_mul_f32 v[12:13], v[12:13], v[80:81]
    v_pk_mul_f32 v[14:15], v[14:15], v[82:83]
    v_exp_f32 v12, v12
    v_exp_f32 v13, v13
    v_exp_f32 v14, v14
    v_exp_f32 v15, v15
    v_pk_mul_f32 v[16:17], v[80:81], v[112:113]
    v_pk_mul_f32 v[18:19], v[82:83], v[114:115]
    v_pk_add_f32 v[12:13], v[12:13], 1.0 op_sel_hi:[1,0]
    v_pk_add_f32 v[14:15], v[14:15], 1.0 op_sel_hi:[1,0]
    v_rcp_f32 v12, v12
    v_rcp_f32 v13, v13
    v_rcp_f32 v14, v14
    v_rcp_f32 v15, v15
    s_nop 0
    v_pk_mul_f32 v[12:13], v[12:13], v[16:17]
    v_pk_mul_f32 v[14:15], v[14:15], v[18:19]
    v_cvt_pk_bf16_f32 v204, v12, v13
    v_cvt_pk_bf16_f32 v205, v14, v15
    ds_write_b64 v198, v[204:205] offset:4656
    v_pk_mul_f32 v[4:5], v[116:117], v[116:117]
    v_pk_mul_f32 v[6:7], v[118:119], v[118:119]
    v_pk_fma_f32 v[4:5], v[4:5], v[206:207], v[200:201]
    v_pk_fma_f32 v[6:7], v[6:7], v[206:207], v[200:201]
    v_pk_mul_f32 v[4:5], v[4:5], v[116:117]
    v_pk_mul_f32 v[6:7], v[6:7], v[118:119]
    v_exp_f32 v4, v4
    v_exp_f32 v5, v5
    v_exp_f32 v6, v6
    v_exp_f32 v7, v7
    v_pk_mul_f32 v[8:9], v[116:117], v[148:149]
    v_pk_mul_f32 v[10:11], v[118:119], v[150:151]
    v_pk_add_f32 v[4:5], v[4:5], 1.0 op_sel_hi:[1,0]
    v_pk_add_f32 v[6:7], v[6:7], 1.0 op_sel_hi:[1,0]
    v_rcp_f32 v4, v4
    v_rcp_f32 v5, v5
    v_rcp_f32 v6, v6
    v_rcp_f32 v7, v7
    s_nop 0
    v_pk_mul_f32 v[4:5], v[4:5], v[8:9]
    v_pk_mul_f32 v[6:7], v[6:7], v[10:11]
    v_cvt_pk_bf16_f32 v202, v4, v5
    v_cvt_pk_bf16_f32 v203, v6, v7
    ds_write_b64 v198, v[202:203] offset:64
    v_pk_mul_f32 v[12:13], v[120:121], v[120:121]
    v_pk_mul_f32 v[14:15], v[122:123], v[122:123]
    v_pk_fma_f32 v[12:13], v[12:13], v[206:207], v[200:201]
    v_pk_fma_f32 v[14:15], v[14:15], v[206:207], v[200:201]
    v_pk_mul_f32 v[12:13], v[12:13], v[120:121]
    v_pk_mul_f32 v[14:15], v[14:15], v[122:123]
    v_exp_f32 v12, v12
    v_exp_f32 v13, v13
    v_exp_f32 v14, v14
    v_exp_f32 v15, v15
    v_pk_mul_f32 v[16:17], v[120:121], v[152:153]
    v_pk_mul_f32 v[18:19], v[122:123], v[154:155]
    v_pk_add_f32 v[12:13], v[12:13], 1.0 op_sel_hi:[1,0]
    v_pk_add_f32 v[14:15], v[14:15], 1.0 op_sel_hi:[1,0]
    v_rcp_f32 v12, v12
    v_rcp_f32 v13, v13
    v_rcp_f32 v14, v14
    v_rcp_f32 v15, v15
    s_nop 0
    v_pk_mul_f32 v[12:13], v[12:13], v[16:17]
    v_pk_mul_f32 v[14:15], v[14:15], v[18:19]
    v_cvt_pk_bf16_f32 v204, v12, v13
    v_cvt_pk_bf16_f32 v205, v14, v15
    ds_write_b64 v198, v[204:205] offset:80
    v_pk_mul_f32 v[4:5], v[124:125], v[124:125]
    v_pk_mul_f32 v[6:7], v[126:127], v[126:127]
    v_pk_fma_f32 v[4:5], v[4:5], v[206:207], v[200:201]
    v_pk_fma_f32 v[6:7], v[6:7], v[206:207], v[200:201]
    v_pk_mul_f32 v[4:5], v[4:5], v[124:125]
    v_pk_mul_f32 v[6:7], v[6:7], v[126:127]
    v_exp_f32 v4, v4
    v_exp_f32 v5, v5
    v_exp_f32 v6, v6
    v_exp_f32 v7, v7
    v_pk_mul_f32 v[8:9], v[124:125], v[156:157]
    v_pk_mul_f32 v[10:11], v[126:127], v[158:159]
    v_pk_add_f32 v[4:5], v[4:5], 1.0 op_sel_hi:[1,0]
    v_pk_add_f32 v[6:7], v[6:7], 1.0 op_sel_hi:[1,0]
    v_rcp_f32 v4, v4
    v_rcp_f32 v5, v5
    v_rcp_f32 v6, v6
    v_rcp_f32 v7, v7
    s_nop 0
    v_pk_mul_f32 v[4:5], v[4:5], v[8:9]
    v_pk_mul_f32 v[6:7], v[6:7], v[10:11]
    v_cvt_pk_bf16_f32 v202, v4, v5
    v_cvt_pk_bf16_f32 v203, v6, v7
    ds_write_b64 v198, v[202:203] offset:96
    v_pk_mul_f32 v[12:13], v[128:129], v[128:129]
    v_pk_mul_f32 v[14:15], v[130:131], v[130:131]
    v_pk_fma_f32 v[12:13], v[12:13], v[206:207], v[200:201]
    v_pk_fma_f32 v[14:15], v[14:15], v[206:207], v[200:201]
    v_pk_mul_f32 v[12:13], v[12:13], v[128:129]
    v_pk_mul_f32 v[14:15], v[14:15], v[130:131]
    v_exp_f32 v12, v12
    v_exp_f32 v13, v13
    v_exp_f32 v14, v14
    v_exp_f32 v15, v15
    v_pk_mul_f32 v[16:17], v[128:129], v[160:161]
    v_pk_mul_f32 v[18:19], v[130:131], v[162:163]
    v_pk_add_f32 v[12:13], v[12:13], 1.0 op_sel_hi:[1,0]
    v_pk_add_f32 v[14:15], v[14:15], 1.0 op_sel_hi:[1,0]
    v_rcp_f32 v12, v12
    v_rcp_f32 v13, v13
    v_rcp_f32 v14, v14
    v_rcp_f32 v15, v15
    s_nop 0
    v_pk_mul_f32 v[12:13], v[12:13], v[16:17]
    v_pk_mul_f32 v[14:15], v[14:15], v[18:19]
    v_cvt_pk_bf16_f32 v204, v12, v13
    v_cvt_pk_bf16_f32 v205, v14, v15
    ds_write_b64 v198, v[204:205] offset:112
    v_pk_mul_f32 v[4:5], v[132:133], v[132:133]
    v_pk_mul_f32 v[6:7], v[134:135], v[134:135]
    v_pk_fma_f32 v[4:5], v[4:5], v[206:207], v[200:201]
    v_pk_fma_f32 v[6:7], v[6:7], v[206:207], v[200:201]
    v_pk_mul_f32 v[4:5], v[4:5], v[132:133]
    v_pk_mul_f32 v[6:7], v[6:7], v[134:135]
    v_exp_f32 v4, v4
    v_exp_f32 v5, v5
    v_exp_f32 v6, v6
    v_exp_f32 v7, v7
    v_pk_mul_f32 v[8:9], v[132:133], v[164:165]
    v_pk_mul_f32 v[10:11], v[134:135], v[166:167]
    v_pk_add_f32 v[4:5], v[4:5], 1.0 op_sel_hi:[1,0]
    v_pk_add_f32 v[6:7], v[6:7], 1.0 op_sel_hi:[1,0]
    v_rcp_f32 v4, v4
    v_rcp_f32 v5, v5
    v_rcp_f32 v6, v6
    v_rcp_f32 v7, v7
    s_nop 0
    v_pk_mul_f32 v[4:5], v[4:5], v[8:9]
    v_pk_mul_f32 v[6:7], v[6:7], v[10:11]
    v_cvt_pk_bf16_f32 v202, v4, v5
    v_cvt_pk_bf16_f32 v203, v6, v7
    ds_write_b64 v198, v[202:203] offset:4672
    v_pk_mul_f32 v[12:13], v[136:137], v[136:137]
    v_pk_mul_f32 v[14:15], v[138:139], v[138:139]
    v_pk_fma_f32 v[12:13], v[12:13], v[206:207], v[200:201]
    v_pk_fma_f32 v[14:15], v[14:15], v[206:207], v[200:201]
    v_pk_mul_f32 v[12:13], v[12:13], v[136:137]
    v_pk_mul_f32 v[14:15], v[14:15], v[138:139]
    v_exp_f32 v12, v12
    v_exp_f32 v13, v13
    v_exp_f32 v14, v14
    v_exp_f32 v15, v15
    v_pk_mul_f32 v[16:17], v[136:137], v[168:169]
    v_pk_mul_f32 v[18:19], v[138:139], v[170:171]
    v_pk_add_f32 v[12:13], v[12:13], 1.0 op_sel_hi:[1,0]
    v_pk_add_f32 v[14:15], v[14:15], 1.0 op_sel_hi:[1,0]
    v_rcp_f32 v12, v12
    v_rcp_f32 v13, v13
    v_rcp_f32 v14, v14
    v_rcp_f32 v15, v15
    s_nop 0
    v_pk_mul_f32 v[12:13], v[12:13], v[16:17]
    v_pk_mul_f32 v[14:15], v[14:15], v[18:19]
    v_cvt_pk_bf16_f32 v204, v12, v13
    v_cvt_pk_bf16_f32 v205, v14, v15
    ds_write_b64 v198, v[204:205] offset:4688
    v_pk_mul_f32 v[4:5], v[140:141], v[140:141]
    v_pk_mul_f32 v[6:7], v[142:143], v[142:143]
    v_pk_fma_f32 v[4:5], v[4:5], v[206:207], v[200:201]
    v_pk_fma_f32 v[6:7], v[6:7], v[206:207], v[200:201]
    v_pk_mul_f32 v[4:5], v[4:5], v[140:141]
    v_pk_mul_f32 v[6:7], v[6:7], v[142:143]
    v_exp_f32 v4, v4
    v_exp_f32 v5, v5
    v_exp_f32 v6, v6
    v_exp_f32 v7, v7
    v_pk_mul_f32 v[8:9], v[140:141], v[172:173]
    v_pk_mul_f32 v[10:11], v[142:143], v[174:175]
    v_pk_add_f32 v[4:5], v[4:5], 1.0 op_sel_hi:[1,0]
    v_pk_add_f32 v[6:7], v[6:7], 1.0 op_sel_hi:[1,0]
    v_rcp_f32 v4, v4
    v_rcp_f32 v5, v5
    v_rcp_f32 v6, v6
    v_rcp_f32 v7, v7
    s_nop 0
    v_pk_mul_f32 v[4:5], v[4:5], v[8:9]
    v_pk_mul_f32 v[6:7], v[6:7], v[10:11]
    v_cvt_pk_bf16_f32 v202, v4, v5
    v_cvt_pk_bf16_f32 v203, v6, v7
    ds_write_b64 v198, v[202:203] offset:4704
    v_pk_mul_f32 v[12:13], v[144:145], v[144:145]
    v_pk_mul_f32 v[14:15], v[146:147], v[146:147]
    v_pk_fma_f32 v[12:13], v[12:13], v[206:207], v[200:201]
    v_pk_fma_f32 v[14:15], v[14:15], v[206:207], v[200:201]
    v_pk_mul_f32 v[12:13], v[12:13], v[144:145]
    v_pk_mul_f32 v[14:15], v[14:15], v[146:147]
    v_exp_f32 v12, v12
    v_exp_f32 v13, v13
    v_exp_f32 v14, v14
    v_exp_f32 v15, v15
    v_pk_mul_f32 v[16:17], v[144:145], v[176:177]
    v_pk_mul_f32 v[18:19], v[146:147], v[178:179]
    v_pk_add_f32 v[12:13], v[12:13], 1.0 op_sel_hi:[1,0]
    v_pk_add_f32 v[14:15], v[14:15], 1.0 op_sel_hi:[1,0]
    v_rcp_f32 v12, v12
    v_rcp_f32 v13, v13
    v_rcp_f32 v14, v14
    v_rcp_f32 v15, v15
    s_nop 0
    v_pk_mul_f32 v[12:13], v[12:13], v[16:17]
    v_pk_mul_f32 v[14:15], v[14:15], v[18:19]
    v_cvt_pk_bf16_f32 v204, v12, v13
    v_cvt_pk_bf16_f32 v205, v14, v15
    ds_write_b64 v198, v[204:205] offset:4720
    v_lshrrev_b32 v199, 3, v1
    v_and_b32 v200, 7, v1
    v_lshlrev_b32 v200, 4, v200
    v_mul_u32_u24 v201, 144, v199
    v_add3_u32 v201, v201, v200, s36
    v_lshlrev_b32 v199, 12, v199
    v_add_u32 v199, v199, v200
    s_lshl_b32 s30, s29, 6
    s_add_u32 s30, s30, s25
    s_lshl_b32 s30, s30, 12
    s_lshl_b32 s37, s28, 7
    s_add_u32 s37, s37, s24
    s_add_u32 s30, s30, s37
    s_waitcnt lgkmcnt(0)

    ds_read_b128 v[52:55], v201 offset:0
    ds_read_b128 v[56:59], v201 offset:1152
    ds_read_b128 v[60:63], v201 offset:2304
    ds_read_b128 v[64:67], v201 offset:3456
    ds_read_b128 v[68:71], v201 offset:4608
    ds_read_b128 v[72:75], v201 offset:5760
    ds_read_b128 v[76:79], v201 offset:6912
    ds_read_b128 v[80:83], v201 offset:8064
    s_waitcnt lgkmcnt(7)
    buffer_store_dwordx4 v[52:55], v199, s[32:35], s30 offen
    s_add_u32 s30, s30, 0x8000
    s_waitcnt lgkmcnt(6)
    buffer_store_dwordx4 v[56:59], v199, s[32:35], s30 offen
    s_add_u32 s30, s30, 0x8000
    s_waitcnt lgkmcnt(5)
    buffer_store_dwordx4 v[60:63], v199, s[32:35], s30 offen
    s_add_u32 s30, s30, 0x8000
    s_waitcnt lgkmcnt(4)
    buffer_store_dwordx4 v[64:67], v199, s[32:35], s30 offen
    s_add_u32 s30, s30, 0x8000
    s_waitcnt lgkmcnt(3)
    buffer_store_dwordx4 v[68:71], v199, s[32:35], s30 offen
    s_add_u32 s30, s30, 0x8000
    s_waitcnt lgkmcnt(2)
    buffer_store_dwordx4 v[72:75], v199, s[32:35], s30 offen
    s_add_u32 s30, s30, 0x8000
    s_waitcnt lgkmcnt(1)
    buffer_store_dwordx4 v[76:79], v199, s[32:35], s30 offen
    s_add_u32 s30, s30, 0x8000
    s_waitcnt lgkmcnt(0)
    buffer_store_dwordx4 v[80:83], v199, s[32:35], s30 offen
    s_add_u32 s30, s30, 0x8000
    s_endpgm
L_g1_pf:
    s_load_dwordx4 s[48:51], s[0:1], 8
    v_and_b32 v1, 63, v0
    v_lshrrev_b32 v2, 6, v0
    s_nop 0
    v_readfirstlane_b32 s3, v2
    s_sub_u32 s38, s2, 240
    s_lshl_b32 s38, s38, 3
    s_nop 2
    s_add_u32 s38, s38, s3
    s_lshl_b32 s38, s38, 16
    v_lshlrev_b32 v3, 4, v1
    s_mov_b32 s39, 0
    s_waitcnt lgkmcnt(0)

    s_mov_b32 s52, s48
    s_mov_b32 s53, s49
    s_mov_b32 s54, 8388608
    s_mov_b32 s55, 0x00020000
    s_mov_b32 s56, s50
    s_mov_b32 s57, s51
    s_mov_b32 s58, 8388608
    s_mov_b32 s59, 0x00020000
L_g1_pfl:
    buffer_load_dwordx4 v[4:7], v3, s[52:55], s38 offen offset:0
    buffer_load_dwordx4 v[8:11], v3, s[56:59], s38 offen offset:0
    buffer_load_dwordx4 v[12:15], v3, s[52:55], s38 offen offset:1024
    buffer_load_dwordx4 v[16:19], v3, s[56:59], s38 offen offset:1024
    buffer_load_dwordx4 v[20:23], v3, s[52:55], s38 offen offset:2048
    buffer_load_dwordx4 v[24:27], v3, s[56:59], s38 offen offset:2048
    buffer_load_dwordx4 v[28:31], v3, s[52:55], s38 offen offset:3072
    buffer_load_dwordx4 v[32:35], v3, s[56:59], s38 offen offset:3072
    s_add_u32 s38, s38, 4096
    s_add_u32 s39, s39, 1
    s_cmp_lt_u32 s39, 16
    s_cbranch_scc1 L_g1_pfl

L_g1_end:
    s_endpgm
.globl gemm2_kernel
.p2align 8
.type gemm2_kernel,@function
gemm2_kernel:
    s_cmp_ge_u32 s2, 256
    s_cbranch_scc1 L_g2_end

    s_load_dwordx4 s[40:43], s[0:1], 8
    s_load_dwordx2 s[44:45], s[0:1], 88
    s_load_dwordx2 s[48:49], s[0:1], 0
    s_load_dwordx4 s[52:55], s[0:1], 72

    s_and_b32 s23, s2, 3
    s_lshr_b32 s20, s2, 2
    s_and_b32 s20, s20, 1
    s_lshl_b32 s20, s20, 3
    s_lshr_b32 s21, s2, 3
    s_and_b32 s22, s21, 7
    s_add_u32 s20, s20, s22
    s_lshr_b32 s22, s21, 3
    s_lshl_b32 s28, s20, 2
    s_add_u32 s28, s28, s22

    s_mul_i32 s17, s23, 86
    s_add_u32 s18, s17, 86
    s_lshr_b32 s17, s17, 2
    s_lshr_b32 s18, s18, 2
    s_sub_u32 s16, s18, s17
    s_mul_i32 s24, s22, 128
    s_lshl_b32 s25, s20, 7
    s_waitcnt lgkmcnt(0)

    s_add_u32 s4, s44, 8388608
    s_addc_u32 s5, s45, 0
    s_mov_b32 s6, 6291456
    s_mov_b32 s7, 0x00020000
    s_add_u32 s46, s44, 16777216
    s_addc_u32 s47, s45, 0
    s_mov_b32 s10, 8388608
    s_mov_b32 s11, 0x00020000

    v_and_b32 v1, 63, v0
    v_lshrrev_b32 v2, 6, v0
    s_nop 0
    v_readfirstlane_b32 s19, v2
    s_nop 3
    s_mov_b32 s15, 0
    s_cmp_lt_u32 s19, 4
    s_cbranch_scc1 L_g2_compute

    s_sub_u32 s14, s19, 4
    s_lshl_b32 s39, s14, 12
    s_mul_i32 s30, s14, 32
    s_lshl_b32 s31, s14, 5
    s_mul_i32 s14, s14, 4096
    v_lshrrev_b32 v20, 3, v1
    v_and_b32 v22, 7, v1
    v_lshrrev_b32 v23, 4, v1
    v_xor_b32 v22, v22, v23

    v_add_u32 v24, s24, v20
    v_add_u32 v24, s30, v24
    v_lshlrev_b32 v24, 12, v24
    v_mov_b32 v25, v22
    v_lshlrev_b32 v25, 4, v25
    v_add_u32 v4, v24, v25
    v_add_u32 v24, s24, v20
    v_add_u32 v24, s30, v24
    v_add_u32 v24, 8, v24
    v_lshlrev_b32 v24, 12, v24
    v_xor_b32 v25, 4, v22
    v_lshlrev_b32 v25, 4, v25
    v_add_u32 v5, v24, v25
    v_subrev_u32 v5, 1024, v5
    v_add_u32 v24, s24, v20
    v_add_u32 v24, s30, v24
    v_add_u32 v24, 16, v24
    v_lshlrev_b32 v24, 12, v24
    v_mov_b32 v25, v22
    v_lshlrev_b32 v25, 4, v25
    v_add_u32 v6, v24, v25
    v_subrev_u32 v6, 2048, v6
    v_add_u32 v24, s24, v20
    v_add_u32 v24, s30, v24
    v_add_u32 v24, 24, v24
    v_lshlrev_b32 v24, 12, v24
    v_xor_b32 v25, 4, v22
    v_lshlrev_b32 v25, 4, v25
    v_add_u32 v7, v24, v25
    v_subrev_u32 v7, 3072, v7
    v_add_u32 v24, s25, v20
    v_add_u32 v24, s31, v24
    v_lshlrev_b32 v24, 12, v24
    v_mov_b32 v25, v22
    v_lshlrev_b32 v25, 4, v25
    v_add_u32 v12, v24, v25
    v_add_u32 v24, s25, v20
    v_add_u32 v24, s31, v24
    v_add_u32 v24, 8, v24
    v_lshlrev_b32 v24, 12, v24
    v_xor_b32 v25, 4, v22
    v_lshlrev_b32 v25, 4, v25
    v_add_u32 v13, v24, v25
    v_subrev_u32 v13, 1024, v13
    v_add_u32 v24, s25, v20
    v_add_u32 v24, s31, v24
    v_add_u32 v24, 16, v24
    v_lshlrev_b32 v24, 12, v24
    v_mov_b32 v25, v22
    v_lshlrev_b32 v25, 4, v25
    v_add_u32 v14, v24, v25
    v_subrev_u32 v14, 2048, v14
    v_add_u32 v24, s25, v20
    v_add_u32 v24, s31, v24
    v_add_u32 v24, 24, v24
    v_lshlrev_b32 v24, 12, v24
    v_xor_b32 v25, 4, v22
    v_lshlrev_b32 v25, 4, v25
    v_add_u32 v15, v24, v25
    v_subrev_u32 v15, 3072, v15
    s_lshr_b32 s26, s17, 5
    s_and_b32 s13, s17, 31
    s_lshl_b32 s13, s13, 7
    s_lshl_b32 s27, s26, 21
    s_add_u32 s12, s13, s27
    s_cmp_eq_u32 s26, 0
    s_cselect_b64 s[8:9], s[40:41], s[42:43]
    s_cmp_ge_u32 s26, 2
    s_cselect_b64 s[8:9], s[46:47], s[8:9]
    s_add_u32 s17, s17, 1

    s_add_u32 m0, s14, 0
    s_nop 0
    buffer_load_dwordx4 v4, s[4:7], s12 offen offset:0 lds
    buffer_load_dwordx4 v5, s[4:7], s12 offen offset:1024 lds
    buffer_load_dwordx4 v6, s[4:7], s12 offen offset:2048 lds
    buffer_load_dwordx4 v7, s[4:7], s12 offen offset:3072 lds
    s_add_u32 m0, s39, 65536
    s_nop 0
    buffer_load_dwordx4 v12, s[8:11], s13 offen offset:0 lds
    buffer_load_dwordx4 v13, s[8:11], s13 offen offset:1024 lds
    buffer_load_dwordx4 v14, s[8:11], s13 offen offset:2048 lds
    buffer_load_dwordx4 v15, s[8:11], s13 offen offset:3072 lds
    s_lshr_b32 s26, s17, 5
    s_and_b32 s13, s17, 31
    s_lshl_b32 s13, s13, 7
    s_lshl_b32 s27, s26, 21
    s_add_u32 s12, s13, s27
    s_cmp_eq_u32 s26, 0
    s_cselect_b64 s[8:9], s[40:41], s[42:43]
    s_cmp_ge_u32 s26, 2
    s_cselect_b64 s[8:9], s[46:47], s[8:9]
    s_add_u32 s17, s17, 1

    s_add_u32 m0, s14, 16384
    s_nop 0
    buffer_load_dwordx4 v4, s[4:7], s12 offen offset:0 lds
    buffer_load_dwordx4 v5, s[4:7], s12 offen offset:1024 lds
    buffer_load_dwordx4 v6, s[4:7], s12 offen offset:2048 lds
    buffer_load_dwordx4 v7, s[4:7], s12 offen offset:3072 lds
    s_add_u32 m0, s39, 81920
    s_nop 0
    buffer_load_dwordx4 v12, s[8:11], s13 offen offset:0 lds
    buffer_load_dwordx4 v13, s[8:11], s13 offen offset:1024 lds
    buffer_load_dwordx4 v14, s[8:11], s13 offen offset:2048 lds
    buffer_load_dwordx4 v15, s[8:11], s13 offen offset:3072 lds
    s_lshr_b32 s26, s17, 5
    s_and_b32 s13, s17, 31
    s_lshl_b32 s13, s13, 7
    s_lshl_b32 s27, s26, 21
    s_add_u32 s12, s13, s27
    s_cmp_eq_u32 s26, 0
    s_cselect_b64 s[8:9], s[40:41], s[42:43]
    s_cmp_ge_u32 s26, 2
    s_cselect_b64 s[8:9], s[46:47], s[8:9]
    s_add_u32 s17, s17, 1

    s_add_u32 m0, s14, 32768
    s_nop 0
    buffer_load_dwordx4 v4, s[4:7], s12 offen offset:0 lds
    buffer_load_dwordx4 v5, s[4:7], s12 offen offset:1024 lds
    buffer_load_dwordx4 v6, s[4:7], s12 offen offset:2048 lds
    buffer_load_dwordx4 v7, s[4:7], s12 offen offset:3072 lds
    s_add_u32 m0, s39, 98304
    s_nop 0
    buffer_load_dwordx4 v12, s[8:11], s13 offen offset:0 lds
    buffer_load_dwordx4 v13, s[8:11], s13 offen offset:1024 lds
    buffer_load_dwordx4 v14, s[8:11], s13 offen offset:2048 lds
    buffer_load_dwordx4 v15, s[8:11], s13 offen offset:3072 lds
    s_waitcnt vmcnt(16)
    s_barrier

L_g2_lloop:
    s_cmp_ge_u32 s17, s18
    s_cbranch_scc1 L_g2_lskip0
    s_lshr_b32 s26, s17, 5
    s_and_b32 s13, s17, 31
    s_lshl_b32 s13, s13, 7
    s_lshl_b32 s27, s26, 21
    s_add_u32 s12, s13, s27
    s_cmp_eq_u32 s26, 0
    s_cselect_b64 s[8:9], s[40:41], s[42:43]
    s_cmp_ge_u32 s26, 2
    s_cselect_b64 s[8:9], s[46:47], s[8:9]
    s_add_u32 s17, s17, 1

    s_add_u32 m0, s14, 49152
    s_nop 0
    buffer_load_dwordx4 v4, s[4:7], s12 offen offset:0 lds
    buffer_load_dwordx4 v5, s[4:7], s12 offen offset:1024 lds
    buffer_load_dwordx4 v6, s[4:7], s12 offen offset:2048 lds
    buffer_load_dwordx4 v7, s[4:7], s12 offen offset:3072 lds
    s_add_u32 m0, s39, 114688
    s_nop 0
    buffer_load_dwordx4 v12, s[8:11], s13 offen offset:0 lds
    buffer_load_dwordx4 v13, s[8:11], s13 offen offset:1024 lds
    buffer_load_dwordx4 v14, s[8:11], s13 offen offset:2048 lds
    buffer_load_dwordx4 v15, s[8:11], s13 offen offset:3072 lds
    s_waitcnt vmcnt(16)
    s_branch L_g2_lbar0
L_g2_lskip0:
    s_waitcnt vmcnt(0)
L_g2_lbar0:
    s_barrier
    s_add_u32 s15, s15, 1
    s_cmp_ge_u32 s15, s16
    s_cbranch_scc1 L_g2_ldone
    s_cmp_ge_u32 s17, s18
    s_cbranch_scc1 L_g2_lskip1
    s_lshr_b32 s26, s17, 5
    s_and_b32 s13, s17, 31
    s_lshl_b32 s13, s13, 7
    s_lshl_b32 s27, s26, 21
    s_add_u32 s12, s13, s27
    s_cmp_eq_u32 s26, 0
    s_cselect_b64 s[8:9], s[40:41], s[42:43]
    s_cmp_ge_u32 s26, 2
    s_cselect_b64 s[8:9], s[46:47], s[8:9]
    s_add_u32 s17, s17, 1

    s_add_u32 m0, s14, 0
    s_nop 0
    buffer_load_dwordx4 v4, s[4:7], s12 offen offset:0 lds
    buffer_load_dwordx4 v5, s[4:7], s12 offen offset:1024 lds
    buffer_load_dwordx4 v6, s[4:7], s12 offen offset:2048 lds
    buffer_load_dwordx4 v7, s[4:7], s12 offen offset:3072 lds
    s_add_u32 m0, s39, 65536
    s_nop 0
    buffer_load_dwordx4 v12, s[8:11], s13 offen offset:0 lds
    buffer_load_dwordx4 v13, s[8:11], s13 offen offset:1024 lds
    buffer_load_dwordx4 v14, s[8:11], s13 offen offset:2048 lds
    buffer_load_dwordx4 v15, s[8:11], s13 offen offset:3072 lds
    s_waitcnt vmcnt(16)
    s_branch L_g2_lbar1
L_g2_lskip1:
    s_waitcnt vmcnt(0)
L_g2_lbar1:
    s_barrier
    s_add_u32 s15, s15, 1
    s_cmp_ge_u32 s15, s16
    s_cbranch_scc1 L_g2_ldone
    s_cmp_ge_u32 s17, s18
    s_cbranch_scc1 L_g2_lskip2
    s_lshr_b32 s26, s17, 5
    s_and_b32 s13, s17, 31
    s_lshl_b32 s13, s13, 7
    s_lshl_b32 s27, s26, 21
    s_add_u32 s12, s13, s27
    s_cmp_eq_u32 s26, 0
    s_cselect_b64 s[8:9], s[40:41], s[42:43]
    s_cmp_ge_u32 s26, 2
    s_cselect_b64 s[8:9], s[46:47], s[8:9]
    s_add_u32 s17, s17, 1

    s_add_u32 m0, s14, 16384
    s_nop 0
    buffer_load_dwordx4 v4, s[4:7], s12 offen offset:0 lds
    buffer_load_dwordx4 v5, s[4:7], s12 offen offset:1024 lds
    buffer_load_dwordx4 v6, s[4:7], s12 offen offset:2048 lds
    buffer_load_dwordx4 v7, s[4:7], s12 offen offset:3072 lds
    s_add_u32 m0, s39, 81920
    s_nop 0
    buffer_load_dwordx4 v12, s[8:11], s13 offen offset:0 lds
    buffer_load_dwordx4 v13, s[8:11], s13 offen offset:1024 lds
    buffer_load_dwordx4 v14, s[8:11], s13 offen offset:2048 lds
    buffer_load_dwordx4 v15, s[8:11], s13 offen offset:3072 lds
    s_waitcnt vmcnt(16)
    s_branch L_g2_lbar2
L_g2_lskip2:
    s_waitcnt vmcnt(0)
L_g2_lbar2:
    s_barrier
    s_add_u32 s15, s15, 1
    s_cmp_ge_u32 s15, s16
    s_cbranch_scc1 L_g2_ldone
    s_cmp_ge_u32 s17, s18
    s_cbranch_scc1 L_g2_lskip3
    s_lshr_b32 s26, s17, 5
    s_and_b32 s13, s17, 31
    s_lshl_b32 s13, s13, 7
    s_lshl_b32 s27, s26, 21
    s_add_u32 s12, s13, s27
    s_cmp_eq_u32 s26, 0
    s_cselect_b64 s[8:9], s[40:41], s[42:43]
    s_cmp_ge_u32 s26, 2
    s_cselect_b64 s[8:9], s[46:47], s[8:9]
    s_add_u32 s17, s17, 1

    s_add_u32 m0, s14, 32768
    s_nop 0
    buffer_load_dwordx4 v4, s[4:7], s12 offen offset:0 lds
    buffer_load_dwordx4 v5, s[4:7], s12 offen offset:1024 lds
    buffer_load_dwordx4 v6, s[4:7], s12 offen offset:2048 lds
    buffer_load_dwordx4 v7, s[4:7], s12 offen offset:3072 lds
    s_add_u32 m0, s39, 98304
    s_nop 0
    buffer_load_dwordx4 v12, s[8:11], s13 offen offset:0 lds
    buffer_load_dwordx4 v13, s[8:11], s13 offen offset:1024 lds
    buffer_load_dwordx4 v14, s[8:11], s13 offen offset:2048 lds
    buffer_load_dwordx4 v15, s[8:11], s13 offen offset:3072 lds
    s_waitcnt vmcnt(16)
    s_branch L_g2_lbar3
L_g2_lskip3:
    s_waitcnt vmcnt(0)
L_g2_lbar3:
    s_barrier
    s_add_u32 s15, s15, 1
    s_cmp_ge_u32 s15, s16
    s_cbranch_scc0 L_g2_lloop
L_g2_ldone:
    s_endpgm
L_g2_compute:
    v_and_b32 v108, 31, v1
    v_lshrrev_b32 v109, 5, v1
    v_lshrrev_b32 v110, 1, v1
    v_and_b32 v110, 7, v110
    v_xor_b32 v110, v110, v109

    v_lshrrev_b32 v111, 1, v2
    v_mul_u32_u24 v111, 64, v111
    v_add_u32 v111, v111, v108
    v_lshlrev_b32 v111, 7, v111
    v_and_b32 v112, 1, v2
    v_lshlrev_b32 v112, 6, v112
    v_add_u32 v112, v112, v108
    v_lshlrev_b32 v112, 7, v112

    v_xor_b32 v113, 0, v110
    v_lshlrev_b32 v113, 4, v113
    v_add_u32 v100, v111, v113
    v_xor_b32 v113, 2, v110
    v_lshlrev_b32 v113, 4, v113
    v_add_u32 v101, v111, v113
    v_xor_b32 v113, 4, v110
    v_lshlrev_b32 v113, 4, v113
    v_add_u32 v102, v111, v113
    v_xor_b32 v113, 6, v110
    v_lshlrev_b32 v113, 4, v113
    v_add_u32 v103, v111, v113
    v_xor_b32 v113, 0, v110
    v_lshlrev_b32 v113, 4, v113
    v_add_u32 v104, v112, v113
    v_add_u32 v104, 65536, v104
    v_xor_b32 v113, 2, v110
    v_lshlrev_b32 v113, 4, v113
    v_add_u32 v105, v112, v113
    v_add_u32 v105, 65536, v105
    v_xor_b32 v113, 4, v110
    v_lshlrev_b32 v113, 4, v113
    v_add_u32 v106, v112, v113
    v_add_u32 v106, 65536, v106
    v_xor_b32 v113, 6, v110
    v_lshlrev_b32 v113, 4, v113
    v_add_u32 v107, v112, v113
    v_add_u32 v107, 65536, v107
    v_mov_b32 v36, 0
    v_mov_b32 v37, 0
    v_mov_b32 v38, 0
    v_mov_b32 v39, 0
    v_mov_b32 v40, 0
    v_mov_b32 v41, 0
    v_mov_b32 v42, 0
    v_mov_b32 v43, 0
    v_mov_b32 v44, 0
    v_mov_b32 v45, 0
    v_mov_b32 v46, 0
    v_mov_b32 v47, 0
    v_mov_b32 v48, 0
    v_mov_b32 v49, 0
    v_mov_b32 v50, 0
    v_mov_b32 v51, 0
    v_mov_b32 v52, 0
    v_mov_b32 v53, 0
    v_mov_b32 v54, 0
    v_mov_b32 v55, 0
    v_mov_b32 v56, 0
    v_mov_b32 v57, 0
    v_mov_b32 v58, 0
    v_mov_b32 v59, 0
    v_mov_b32 v60, 0
    v_mov_b32 v61, 0
    v_mov_b32 v62, 0
    v_mov_b32 v63, 0
    v_mov_b32 v64, 0
    v_mov_b32 v65, 0
    v_mov_b32 v66, 0
    v_mov_b32 v67, 0
    v_mov_b32 v68, 0
    v_mov_b32 v69, 0
    v_mov_b32 v70, 0
    v_mov_b32 v71, 0
    v_mov_b32 v72, 0
    v_mov_b32 v73, 0
    v_mov_b32 v74, 0
    v_mov_b32 v75, 0
    v_mov_b32 v76, 0
    v_mov_b32 v77, 0
    v_mov_b32 v78, 0
    v_mov_b32 v79, 0
    v_mov_b32 v80, 0
    v_mov_b32 v81, 0
    v_mov_b32 v82, 0
    v_mov_b32 v83, 0
    v_mov_b32 v84, 0
    v_mov_b32 v85, 0
    v_mov_b32 v86, 0
    v_mov_b32 v87, 0
    v_mov_b32 v88, 0
    v_mov_b32 v89, 0
    v_mov_b32 v90, 0
    v_mov_b32 v91, 0
    v_mov_b32 v92, 0
    v_mov_b32 v93, 0
    v_mov_b32 v94, 0
    v_mov_b32 v95, 0
    v_mov_b32 v96, 0
    v_mov_b32 v97, 0
    v_mov_b32 v98, 0
    v_mov_b32 v99, 0
    s_barrier
    ds_read_b128 v[4:7], v100 offset:0
    ds_read_b128 v[8:11], v100 offset:4096
    ds_read_b128 v[12:15], v104 offset:0
    ds_read_b128 v[16:19], v104 offset:4096
L_g2_loop:
    ds_read_b128 v[20:23], v101 offset:0
    ds_read_b128 v[24:27], v101 offset:4096
    ds_read_b128 v[28:31], v105 offset:0
    ds_read_b128 v[32:35], v105 offset:4096
    s_waitcnt lgkmcnt(4)
    v_mfma_f32_32x32x16_bf16 v[36:51], v[4:7], v[12:15], v[36:51]
    v_mfma_f32_32x32x16_bf16 v[52:67], v[4:7], v[16:19], v[52:67]
    v_mfma_f32_32x32x16_bf16 v[68:83], v[8:11], v[12:15], v[68:83]
    v_mfma_f32_32x32x16_bf16 v[84:99], v[8:11], v[16:19], v[84:99]
    ds_read_b128 v[4:7], v102 offset:0
    ds_read_b128 v[8:11], v102 offset:4096
    ds_read_b128 v[12:15], v106 offset:0
    ds_read_b128 v[16:19], v106 offset:4096
    s_waitcnt lgkmcnt(4)
    v_mfma_f32_32x32x16_bf16 v[36:51], v[20:23], v[28:31], v[36:51]
    v_mfma_f32_32x32x16_bf16 v[52:67], v[20:23], v[32:35], v[52:67]
    v_mfma_f32_32x32x16_bf16 v[68:83], v[24:27], v[28:31], v[68:83]
    v_mfma_f32_32x32x16_bf16 v[84:99], v[24:27], v[32:35], v[84:99]
    ds_read_b128 v[20:23], v103 offset:0
    ds_read_b128 v[24:27], v103 offset:4096
    ds_read_b128 v[28:31], v107 offset:0
    ds_read_b128 v[32:35], v107 offset:4096
    s_waitcnt lgkmcnt(4)
    v_mfma_f32_32x32x16_bf16 v[36:51], v[4:7], v[12:15], v[36:51]
    v_mfma_f32_32x32x16_bf16 v[52:67], v[4:7], v[16:19], v[52:67]
    v_mfma_f32_32x32x16_bf16 v[68:83], v[8:11], v[12:15], v[68:83]
    v_mfma_f32_32x32x16_bf16 v[84:99], v[8:11], v[16:19], v[84:99]
    s_waitcnt lgkmcnt(0)
    s_barrier
    ds_read_b128 v[4:7], v100 offset:16384
    ds_read_b128 v[8:11], v100 offset:20480
    ds_read_b128 v[12:15], v104 offset:16384
    ds_read_b128 v[16:19], v104 offset:20480
    v_mfma_f32_32x32x16_bf16 v[36:51], v[20:23], v[28:31], v[36:51]
    v_mfma_f32_32x32x16_bf16 v[52:67], v[20:23], v[32:35], v[52:67]
    v_mfma_f32_32x32x16_bf16 v[68:83], v[24:27], v[28:31], v[68:83]
    v_mfma_f32_32x32x16_bf16 v[84:99], v[24:27], v[32:35], v[84:99]
    s_add_u32 s15, s15, 1
    s_cmp_ge_u32 s15, s16
    s_cbranch_scc1 L_g2_done
    ds_read_b128 v[20:23], v101 offset:16384
    ds_read_b128 v[24:27], v101 offset:20480
    ds_read_b128 v[28:31], v105 offset:16384
    ds_read_b128 v[32:35], v105 offset:20480
    s_waitcnt lgkmcnt(4)
    v_mfma_f32_32x32x16_bf16 v[36:51], v[4:7], v[12:15], v[36:51]
    v_mfma_f32_32x32x16_bf16 v[52:67], v[4:7], v[16:19], v[52:67]
    v_mfma_f32_32x32x16_bf16 v[68:83], v[8:11], v[12:15], v[68:83]
    v_mfma_f32_32x32x16_bf16 v[84:99], v[8:11], v[16:19], v[84:99]
    ds_read_b128 v[4:7], v102 offset:16384
    ds_read_b128 v[8:11], v102 offset:20480
    ds_read_b128 v[12:15], v106 offset:16384
    ds_read_b128 v[16:19], v106 offset:20480
    s_waitcnt lgkmcnt(4)
    v_mfma_f32_32x32x16_bf16 v[36:51], v[20:23], v[28:31], v[36:51]
    v_mfma_f32_32x32x16_bf16 v[52:67], v[20:23], v[32:35], v[52:67]
    v_mfma_f32_32x32x16_bf16 v[68:83], v[24:27], v[28:31], v[68:83]
    v_mfma_f32_32x32x16_bf16 v[84:99], v[24:27], v[32:35], v[84:99]
    ds_read_b128 v[20:23], v103 offset:16384
    ds_read_b128 v[24:27], v103 offset:20480
    ds_read_b128 v[28:31], v107 offset:16384
    ds_read_b128 v[32:35], v107 offset:20480
    s_waitcnt lgkmcnt(4)
    v_mfma_f32_32x32x16_bf16 v[36:51], v[4:7], v[12:15], v[36:51]
    v_mfma_f32_32x32x16_bf16 v[52:67], v[4:7], v[16:19], v[52:67]
    v_mfma_f32_32x32x16_bf16 v[68:83], v[8:11], v[12:15], v[68:83]
    v_mfma_f32_32x32x16_bf16 v[84:99], v[8:11], v[16:19], v[84:99]
    s_waitcnt lgkmcnt(0)
    s_barrier
    ds_read_b128 v[4:7], v100 offset:32768
    ds_read_b128 v[8:11], v100 offset:36864
    ds_read_b128 v[12:15], v104 offset:32768
    ds_read_b128 v[16:19], v104 offset:36864
    v_mfma_f32_32x32x16_bf16 v[36:51], v[20:23], v[28:31], v[36:51]
    v_mfma_f32_32x32x16_bf16 v[52:67], v[20:23], v[32:35], v[52:67]
    v_mfma_f32_32x32x16_bf16 v[68:83], v[24:27], v[28:31], v[68:83]
    v_mfma_f32_32x32x16_bf16 v[84:99], v[24:27], v[32:35], v[84:99]
    s_add_u32 s15, s15, 1
    s_cmp_ge_u32 s15, s16
    s_cbranch_scc1 L_g2_done
    ds_read_b128 v[20:23], v101 offset:32768
    ds_read_b128 v[24:27], v101 offset:36864
    ds_read_b128 v[28:31], v105 offset:32768
    ds_read_b128 v[32:35], v105 offset:36864
    s_waitcnt lgkmcnt(4)
    v_mfma_f32_32x32x16_bf16 v[36:51], v[4:7], v[12:15], v[36:51]
    v_mfma_f32_32x32x16_bf16 v[52:67], v[4:7], v[16:19], v[52:67]
    v_mfma_f32_32x32x16_bf16 v[68:83], v[8:11], v[12:15], v[68:83]
    v_mfma_f32_32x32x16_bf16 v[84:99], v[8:11], v[16:19], v[84:99]
    ds_read_b128 v[4:7], v102 offset:32768
    ds_read_b128 v[8:11], v102 offset:36864
    ds_read_b128 v[12:15], v106 offset:32768
    ds_read_b128 v[16:19], v106 offset:36864
    s_waitcnt lgkmcnt(4)
    v_mfma_f32_32x32x16_bf16 v[36:51], v[20:23], v[28:31], v[36:51]
    v_mfma_f32_32x32x16_bf16 v[52:67], v[20:23], v[32:35], v[52:67]
    v_mfma_f32_32x32x16_bf16 v[68:83], v[24:27], v[28:31], v[68:83]
    v_mfma_f32_32x32x16_bf16 v[84:99], v[24:27], v[32:35], v[84:99]
    ds_read_b128 v[20:23], v103 offset:32768
    ds_read_b128 v[24:27], v103 offset:36864
    ds_read_b128 v[28:31], v107 offset:32768
    ds_read_b128 v[32:35], v107 offset:36864
    s_waitcnt lgkmcnt(4)
    v_mfma_f32_32x32x16_bf16 v[36:51], v[4:7], v[12:15], v[36:51]
    v_mfma_f32_32x32x16_bf16 v[52:67], v[4:7], v[16:19], v[52:67]
    v_mfma_f32_32x32x16_bf16 v[68:83], v[8:11], v[12:15], v[68:83]
    v_mfma_f32_32x32x16_bf16 v[84:99], v[8:11], v[16:19], v[84:99]
    s_waitcnt lgkmcnt(0)
    s_barrier
    ds_read_b128 v[4:7], v100 offset:49152
    ds_read_b128 v[8:11], v100 offset:53248
    ds_read_b128 v[12:15], v104 offset:49152
    ds_read_b128 v[16:19], v104 offset:53248
    v_mfma_f32_32x32x16_bf16 v[36:51], v[20:23], v[28:31], v[36:51]
    v_mfma_f32_32x32x16_bf16 v[52:67], v[20:23], v[32:35], v[52:67]
    v_mfma_f32_32x32x16_bf16 v[68:83], v[24:27], v[28:31], v[68:83]
    v_mfma_f32_32x32x16_bf16 v[84:99], v[24:27], v[32:35], v[84:99]
    s_add_u32 s15, s15, 1
    s_cmp_ge_u32 s15, s16
    s_cbranch_scc1 L_g2_done
    ds_read_b128 v[20:23], v101 offset:49152
    ds_read_b128 v[24:27], v101 offset:53248
    ds_read_b128 v[28:31], v105 offset:49152
    ds_read_b128 v[32:35], v105 offset:53248
    s_waitcnt lgkmcnt(4)
    v_mfma_f32_32x32x16_bf16 v[36:51], v[4:7], v[12:15], v[36:51]
    v_mfma_f32_32x32x16_bf16 v[52:67], v[4:7], v[16:19], v[52:67]
    v_mfma_f32_32x32x16_bf16 v[68:83], v[8:11], v[12:15], v[68:83]
    v_mfma_f32_32x32x16_bf16 v[84:99], v[8:11], v[16:19], v[84:99]
    ds_read_b128 v[4:7], v102 offset:49152
    ds_read_b128 v[8:11], v102 offset:53248
    ds_read_b128 v[12:15], v106 offset:49152
    ds_read_b128 v[16:19], v106 offset:53248
    s_waitcnt lgkmcnt(4)
    v_mfma_f32_32x32x16_bf16 v[36:51], v[20:23], v[28:31], v[36:51]
    v_mfma_f32_32x32x16_bf16 v[52:67], v[20:23], v[32:35], v[52:67]
    v_mfma_f32_32x32x16_bf16 v[68:83], v[24:27], v[28:31], v[68:83]
    v_mfma_f32_32x32x16_bf16 v[84:99], v[24:27], v[32:35], v[84:99]
    ds_read_b128 v[20:23], v103 offset:49152
    ds_read_b128 v[24:27], v103 offset:53248
    ds_read_b128 v[28:31], v107 offset:49152
    ds_read_b128 v[32:35], v107 offset:53248
    s_waitcnt lgkmcnt(4)
    v_mfma_f32_32x32x16_bf16 v[36:51], v[4:7], v[12:15], v[36:51]
    v_mfma_f32_32x32x16_bf16 v[52:67], v[4:7], v[16:19], v[52:67]
    v_mfma_f32_32x32x16_bf16 v[68:83], v[8:11], v[12:15], v[68:83]
    v_mfma_f32_32x32x16_bf16 v[84:99], v[8:11], v[16:19], v[84:99]
    s_waitcnt lgkmcnt(0)
    s_barrier
    ds_read_b128 v[4:7], v100 offset:0
    ds_read_b128 v[8:11], v100 offset:4096
    ds_read_b128 v[12:15], v104 offset:0
    ds_read_b128 v[16:19], v104 offset:4096
    v_mfma_f32_32x32x16_bf16 v[36:51], v[20:23], v[28:31], v[36:51]
    v_mfma_f32_32x32x16_bf16 v[52:67], v[20:23], v[32:35], v[52:67]
    v_mfma_f32_32x32x16_bf16 v[68:83], v[24:27], v[28:31], v[68:83]
    v_mfma_f32_32x32x16_bf16 v[84:99], v[24:27], v[32:35], v[84:99]
    s_add_u32 s15, s15, 1
    s_cmp_ge_u32 s15, s16
    s_cbranch_scc0 L_g2_loop
L_g2_done:
    s_waitcnt lgkmcnt(0)
    s_nop 15
    s_add_u32 s32, s44, 33554432
    s_addc_u32 s33, s45, 0
    s_mov_b32 s34, 8388608
    s_mov_b32 s35, 0x00020000
    s_add_u32 s56, s44, 31457280
    s_addc_u32 s57, s45, 0
    s_mov_b32 s58, 16384
    s_mov_b32 s59, 0x00020000
    s_mov_b32 s60, s48
    s_mov_b32 s61, s49
    s_mov_b32 s62, 2097152
    s_mov_b32 s63, 0x00020000
    s_mov_b32 s64, s52
    s_mov_b32 s65, s53
    s_mov_b32 s66, 2097152
    s_mov_b32 s67, 0x00020000
    s_lshl_b32 s31, s19, 11
    v_lshlrev_b32 v108, 4, v1
    s_and_b32 s36, s19, 1
    s_lshl_b32 s36, s36, 1
    s_and_b32 s37, s23, 1
    s_add_u32 s36, s36, s37
    s_lshl_b32 s36, s36, 5
    s_add_u32 s36, s36, s25
    s_lshr_b32 s37, s19, 1
    s_mul_i32 s37, s37, 2
    s_lshr_b32 s38, s23, 1
    s_add_u32 s37, s37, s38
    s_lshl_b32 s37, s37, 5
    s_add_u32 s37, s37, s24
    v_and_b32 v109, 31, v1
    v_add_u32 v109, s36, v109
    v_lshlrev_b32 v109, 10, v109
    v_lshrrev_b32 v110, 5, v1
    v_lshlrev_b32 v110, 2, v110
    v_add_u32 v110, s37, v110
    v_lshlrev_b32 v110, 1, v110
    v_add_u32 v109, v109, v110
    s_mov_b32 s36, 0
    s_mov_b32 s37, 0x4000

    s_cmp_eq_u32 s23, 0
    s_cbranch_scc1 L_g2_pub0
    s_lshl_b32 s30, s28, 2
    s_add_u32 s30, s30, 0
    s_lshl_b32 s30, s30, 2
    s_add_u32 s30, s30, s23
    s_lshl_b32 s30, s30, 13
    s_add_u32 s30, s30, s31

    v_cvt_pk_bf16_f32 v112, v36, v37
    v_cvt_pk_bf16_f32 v113, v38, v39
    v_cvt_pk_bf16_f32 v114, v40, v41
    v_cvt_pk_bf16_f32 v115, v42, v43
    v_cvt_pk_bf16_f32 v116, v44, v45
    v_cvt_pk_bf16_f32 v117, v46, v47
    v_cvt_pk_bf16_f32 v118, v48, v49
    v_cvt_pk_bf16_f32 v119, v50, v51
    buffer_store_dwordx4 v[112:115], v108, s[32:35], s30 offen sc1
    buffer_store_dwordx4 v[116:119], v108, s[32:35], s30 offen offset:1024 sc1
L_g2_pub0:
    s_cmp_eq_u32 s23, 1
    s_cbranch_scc1 L_g2_pub1
    s_lshl_b32 s30, s28, 2
    s_add_u32 s30, s30, 1
    s_lshl_b32 s30, s30, 2
    s_add_u32 s30, s30, s23
    s_lshl_b32 s30, s30, 13
    s_add_u32 s30, s30, s31

    v_cvt_pk_bf16_f32 v120, v52, v53
    v_cvt_pk_bf16_f32 v121, v54, v55
    v_cvt_pk_bf16_f32 v122, v56, v57
    v_cvt_pk_bf16_f32 v123, v58, v59
    v_cvt_pk_bf16_f32 v124, v60, v61
    v_cvt_pk_bf16_f32 v125, v62, v63
    v_cvt_pk_bf16_f32 v126, v64, v65
    v_cvt_pk_bf16_f32 v127, v66, v67
    buffer_store_dwordx4 v[120:123], v108, s[32:35], s30 offen sc1
    buffer_store_dwordx4 v[124:127], v108, s[32:35], s30 offen offset:1024 sc1
L_g2_pub1:
    s_cmp_eq_u32 s23, 2
    s_cbranch_scc1 L_g2_pub2
    s_lshl_b32 s30, s28, 2
    s_add_u32 s30, s30, 2
    s_lshl_b32 s30, s30, 2
    s_add_u32 s30, s30, s23
    s_lshl_b32 s30, s30, 13
    s_add_u32 s30, s30, s31

    v_cvt_pk_bf16_f32 v112, v68, v69
    v_cvt_pk_bf16_f32 v113, v70, v71
    v_cvt_pk_bf16_f32 v114, v72, v73
    v_cvt_pk_bf16_f32 v115, v74, v75
    v_cvt_pk_bf16_f32 v116, v76, v77
    v_cvt_pk_bf16_f32 v117, v78, v79
    v_cvt_pk_bf16_f32 v118, v80, v81
    v_cvt_pk_bf16_f32 v119, v82, v83
    buffer_store_dwordx4 v[112:115], v108, s[32:35], s30 offen sc1
    buffer_store_dwordx4 v[116:119], v108, s[32:35], s30 offen offset:1024 sc1
L_g2_pub2:
    s_cmp_eq_u32 s23, 3
    s_cbranch_scc1 L_g2_pub3
    s_lshl_b32 s30, s28, 2
    s_add_u32 s30, s30, 3
    s_lshl_b32 s30, s30, 2
    s_add_u32 s30, s30, s23
    s_lshl_b32 s30, s30, 13
    s_add_u32 s30, s30, s31

    v_cvt_pk_bf16_f32 v120, v84, v85
    v_cvt_pk_bf16_f32 v121, v86, v87
    v_cvt_pk_bf16_f32 v122, v88, v89
    v_cvt_pk_bf16_f32 v123, v90, v91
    v_cvt_pk_bf16_f32 v124, v92, v93
    v_cvt_pk_bf16_f32 v125, v94, v95
    v_cvt_pk_bf16_f32 v126, v96, v97
    v_cvt_pk_bf16_f32 v127, v98, v99
    buffer_store_dwordx4 v[120:123], v108, s[32:35], s30 offen sc1
    buffer_store_dwordx4 v[124:127], v108, s[32:35], s30 offen offset:1024 sc1
L_g2_pub3:
    s_waitcnt vmcnt(0)
    buffer_load_dwordx2 v[128:129], v109, s[60:63], s36 offen offset:0
    buffer_load_dwordx2 v[130:131], v109, s[60:63], s36 offen offset:16
    buffer_load_dwordx2 v[132:133], v109, s[60:63], s36 offen offset:32
    buffer_load_dwordx2 v[134:135], v109, s[60:63], s36 offen offset:48
    s_barrier
    s_cmp_lg_u32 s19, 0
    s_cbranch_scc1 L_g2_wait
    s_lshl_b32 s29, s28, 8
    v_mov_b32 v110, 1
    v_mov_b32 v111, 0
    s_mov_b64 s[68:69], exec
    s_mov_b64 exec, 1
    buffer_atomic_add v110, v111, s[56:59], s29 offen

L_g2_spin:
    buffer_load_dword v110, v111, s[56:59], s29 offen sc1
    s_waitcnt vmcnt(0)
    v_readfirstlane_b32 s30, v110
    s_nop 3
    s_cmp_ge_u32 s30, 4
    s_cbranch_scc1 L_g2_spun
    s_sleep 1
    s_branch L_g2_spin

L_g2_spun:
    s_mov_b64 exec, s[68:69]
L_g2_wait:
    s_barrier
    s_lshl_b32 s38, s28, 2
    s_add_u32 s38, s38, s23
    s_lshl_b32 s38, s38, 2

    s_cmp_eq_u32 s23, 0
    s_cbranch_scc1 L_g2_fin0
    s_cmp_eq_u32 s23, 1
    s_cbranch_scc1 L_g2_fin1
    s_cmp_eq_u32 s23, 2
    s_cbranch_scc1 L_g2_fin2
    s_add_u32 s30, s38, 0
    s_lshl_b32 s30, s30, 13
    s_add_u32 s30, s30, s31

    buffer_load_dwordx4 v[36:39], v108, s[32:35], s30 offen sc1
    buffer_load_dwordx4 v[40:43], v108, s[32:35], s30 offen offset:1024 sc1
    s_add_u32 s30, s38, 1
    s_lshl_b32 s30, s30, 13
    s_add_u32 s30, s30, s31

    buffer_load_dwordx4 v[52:55], v108, s[32:35], s30 offen sc1
    buffer_load_dwordx4 v[56:59], v108, s[32:35], s30 offen offset:1024 sc1
    s_add_u32 s30, s38, 2
    s_lshl_b32 s30, s30, 13
    s_add_u32 s30, s30, s31

    buffer_load_dwordx4 v[68:71], v108, s[32:35], s30 offen sc1
    buffer_load_dwordx4 v[72:75], v108, s[32:35], s30 offen offset:1024 sc1
    s_waitcnt vmcnt(6)
    v_lshlrev_b32 v110, 16, v128
    v_and_b32 v111, 0xffff0000, v128
    v_add_f32 v84, v84, v110
    v_add_f32 v85, v85, v111
    v_lshlrev_b32 v110, 16, v129
    v_and_b32 v111, 0xffff0000, v129
    v_add_f32 v86, v86, v110
    v_add_f32 v87, v87, v111
    v_lshlrev_b32 v110, 16, v130
    v_and_b32 v111, 0xffff0000, v130
    v_add_f32 v88, v88, v110
    v_add_f32 v89, v89, v111
    v_lshlrev_b32 v110, 16, v131
    v_and_b32 v111, 0xffff0000, v131
    v_add_f32 v90, v90, v110
    v_add_f32 v91, v91, v111
    v_lshlrev_b32 v110, 16, v132
    v_and_b32 v111, 0xffff0000, v132
    v_add_f32 v92, v92, v110
    v_add_f32 v93, v93, v111
    v_lshlrev_b32 v110, 16, v133
    v_and_b32 v111, 0xffff0000, v133
    v_add_f32 v94, v94, v110
    v_add_f32 v95, v95, v111
    v_lshlrev_b32 v110, 16, v134
    v_and_b32 v111, 0xffff0000, v134
    v_add_f32 v96, v96, v110
    v_add_f32 v97, v97, v111
    v_lshlrev_b32 v110, 16, v135
    v_and_b32 v111, 0xffff0000, v135
    v_add_f32 v98, v98, v110
    v_add_f32 v99, v99, v111
    s_waitcnt vmcnt(4)
    v_lshlrev_b32 v110, 16, v36
    v_and_b32 v111, 0xffff0000, v36
    v_add_f32 v84, v84, v110
    v_add_f32 v85, v85, v111
    v_lshlrev_b32 v110, 16, v37
    v_and_b32 v111, 0xffff0000, v37
    v_add_f32 v86, v86, v110
    v_add_f32 v87, v87, v111
    v_lshlrev_b32 v110, 16, v38
    v_and_b32 v111, 0xffff0000, v38
    v_add_f32 v88, v88, v110
    v_add_f32 v89, v89, v111
    v_lshlrev_b32 v110, 16, v39
    v_and_b32 v111, 0xffff0000, v39
    v_add_f32 v90, v90, v110
    v_add_f32 v91, v91, v111
    v_lshlrev_b32 v110, 16, v40
    v_and_b32 v111, 0xffff0000, v40
    v_add_f32 v92, v92, v110
    v_add_f32 v93, v93, v111
    v_lshlrev_b32 v110, 16, v41
    v_and_b32 v111, 0xffff0000, v41
    v_add_f32 v94, v94, v110
    v_add_f32 v95, v95, v111
    v_lshlrev_b32 v110, 16, v42
    v_and_b32 v111, 0xffff0000, v42
    v_add_f32 v96, v96, v110
    v_add_f32 v97, v97, v111
    v_lshlrev_b32 v110, 16, v43
    v_and_b32 v111, 0xffff0000, v43
    v_add_f32 v98, v98, v110
    v_add_f32 v99, v99, v111
    s_waitcnt vmcnt(2)
    v_lshlrev_b32 v110, 16, v52
    v_and_b32 v111, 0xffff0000, v52
    v_add_f32 v84, v84, v110
    v_add_f32 v85, v85, v111
    v_lshlrev_b32 v110, 16, v53
    v_and_b32 v111, 0xffff0000, v53
    v_add_f32 v86, v86, v110
    v_add_f32 v87, v87, v111
    v_lshlrev_b32 v110, 16, v54
    v_and_b32 v111, 0xffff0000, v54
    v_add_f32 v88, v88, v110
    v_add_f32 v89, v89, v111
    v_lshlrev_b32 v110, 16, v55
    v_and_b32 v111, 0xffff0000, v55
    v_add_f32 v90, v90, v110
    v_add_f32 v91, v91, v111
    v_lshlrev_b32 v110, 16, v56
    v_and_b32 v111, 0xffff0000, v56
    v_add_f32 v92, v92, v110
    v_add_f32 v93, v93, v111
    v_lshlrev_b32 v110, 16, v57
    v_and_b32 v111, 0xffff0000, v57
    v_add_f32 v94, v94, v110
    v_add_f32 v95, v95, v111
    v_lshlrev_b32 v110, 16, v58
    v_and_b32 v111, 0xffff0000, v58
    v_add_f32 v96, v96, v110
    v_add_f32 v97, v97, v111
    v_lshlrev_b32 v110, 16, v59
    v_and_b32 v111, 0xffff0000, v59
    v_add_f32 v98, v98, v110
    v_add_f32 v99, v99, v111
    s_waitcnt vmcnt(0)
    v_lshlrev_b32 v110, 16, v68
    v_and_b32 v111, 0xffff0000, v68
    v_add_f32 v84, v84, v110
    v_add_f32 v85, v85, v111
    v_lshlrev_b32 v110, 16, v69
    v_and_b32 v111, 0xffff0000, v69
    v_add_f32 v86, v86, v110
    v_add_f32 v87, v87, v111
    v_lshlrev_b32 v110, 16, v70
    v_and_b32 v111, 0xffff0000, v70
    v_add_f32 v88, v88, v110
    v_add_f32 v89, v89, v111
    v_lshlrev_b32 v110, 16, v71
    v_and_b32 v111, 0xffff0000, v71
    v_add_f32 v90, v90, v110
    v_add_f32 v91, v91, v111
    v_lshlrev_b32 v110, 16, v72
    v_and_b32 v111, 0xffff0000, v72
    v_add_f32 v92, v92, v110
    v_add_f32 v93, v93, v111
    v_lshlrev_b32 v110, 16, v73
    v_and_b32 v111, 0xffff0000, v73
    v_add_f32 v94, v94, v110
    v_add_f32 v95, v95, v111
    v_lshlrev_b32 v110, 16, v74
    v_and_b32 v111, 0xffff0000, v74
    v_add_f32 v96, v96, v110
    v_add_f32 v97, v97, v111
    v_lshlrev_b32 v110, 16, v75
    v_and_b32 v111, 0xffff0000, v75
    v_add_f32 v98, v98, v110
    v_add_f32 v99, v99, v111
    v_cvt_pk_bf16_f32 v128, v84, v85
    v_cvt_pk_bf16_f32 v129, v86, v87
    buffer_store_dwordx2 v[128:129], v109, s[64:67], s36 offen offset:0
    v_cvt_pk_bf16_f32 v130, v88, v89
    v_cvt_pk_bf16_f32 v131, v90, v91
    buffer_store_dwordx2 v[130:131], v109, s[64:67], s36 offen offset:16
    v_cvt_pk_bf16_f32 v132, v92, v93
    v_cvt_pk_bf16_f32 v133, v94, v95
    buffer_store_dwordx2 v[132:133], v109, s[64:67], s36 offen offset:32
    v_cvt_pk_bf16_f32 v134, v96, v97
    v_cvt_pk_bf16_f32 v135, v98, v99
    buffer_store_dwordx2 v[134:135], v109, s[64:67], s36 offen offset:48
    s_endpgm
L_g2_fin0:
    s_add_u32 s30, s38, 1
    s_lshl_b32 s30, s30, 13
    s_add_u32 s30, s30, s31

    buffer_load_dwordx4 v[52:55], v108, s[32:35], s30 offen sc1
    buffer_load_dwordx4 v[56:59], v108, s[32:35], s30 offen offset:1024 sc1
    s_add_u32 s30, s38, 2
    s_lshl_b32 s30, s30, 13
    s_add_u32 s30, s30, s31

    buffer_load_dwordx4 v[68:71], v108, s[32:35], s30 offen sc1
    buffer_load_dwordx4 v[72:75], v108, s[32:35], s30 offen offset:1024 sc1
    s_add_u32 s30, s38, 3
    s_lshl_b32 s30, s30, 13
    s_add_u32 s30, s30, s31

    buffer_load_dwordx4 v[84:87], v108, s[32:35], s30 offen sc1
    buffer_load_dwordx4 v[88:91], v108, s[32:35], s30 offen offset:1024 sc1
    s_waitcnt vmcnt(6)
    v_lshlrev_b32 v110, 16, v128
    v_and_b32 v111, 0xffff0000, v128
    v_add_f32 v36, v36, v110
    v_add_f32 v37, v37, v111
    v_lshlrev_b32 v110, 16, v129
    v_and_b32 v111, 0xffff0000, v129
    v_add_f32 v38, v38, v110
    v_add_f32 v39, v39, v111
    v_lshlrev_b32 v110, 16, v130
    v_and_b32 v111, 0xffff0000, v130
    v_add_f32 v40, v40, v110
    v_add_f32 v41, v41, v111
    v_lshlrev_b32 v110, 16, v131
    v_and_b32 v111, 0xffff0000, v131
    v_add_f32 v42, v42, v110
    v_add_f32 v43, v43, v111
    v_lshlrev_b32 v110, 16, v132
    v_and_b32 v111, 0xffff0000, v132
    v_add_f32 v44, v44, v110
    v_add_f32 v45, v45, v111
    v_lshlrev_b32 v110, 16, v133
    v_and_b32 v111, 0xffff0000, v133
    v_add_f32 v46, v46, v110
    v_add_f32 v47, v47, v111
    v_lshlrev_b32 v110, 16, v134
    v_and_b32 v111, 0xffff0000, v134
    v_add_f32 v48, v48, v110
    v_add_f32 v49, v49, v111
    v_lshlrev_b32 v110, 16, v135
    v_and_b32 v111, 0xffff0000, v135
    v_add_f32 v50, v50, v110
    v_add_f32 v51, v51, v111
    s_waitcnt vmcnt(4)
    v_lshlrev_b32 v110, 16, v52
    v_and_b32 v111, 0xffff0000, v52
    v_add_f32 v36, v36, v110
    v_add_f32 v37, v37, v111
    v_lshlrev_b32 v110, 16, v53
    v_and_b32 v111, 0xffff0000, v53
    v_add_f32 v38, v38, v110
    v_add_f32 v39, v39, v111
    v_lshlrev_b32 v110, 16, v54
    v_and_b32 v111, 0xffff0000, v54
    v_add_f32 v40, v40, v110
    v_add_f32 v41, v41, v111
    v_lshlrev_b32 v110, 16, v55
    v_and_b32 v111, 0xffff0000, v55
    v_add_f32 v42, v42, v110
    v_add_f32 v43, v43, v111
    v_lshlrev_b32 v110, 16, v56
    v_and_b32 v111, 0xffff0000, v56
    v_add_f32 v44, v44, v110
    v_add_f32 v45, v45, v111
    v_lshlrev_b32 v110, 16, v57
    v_and_b32 v111, 0xffff0000, v57
    v_add_f32 v46, v46, v110
    v_add_f32 v47, v47, v111
    v_lshlrev_b32 v110, 16, v58
    v_and_b32 v111, 0xffff0000, v58
    v_add_f32 v48, v48, v110
    v_add_f32 v49, v49, v111
    v_lshlrev_b32 v110, 16, v59
    v_and_b32 v111, 0xffff0000, v59
    v_add_f32 v50, v50, v110
    v_add_f32 v51, v51, v111
    s_waitcnt vmcnt(2)
    v_lshlrev_b32 v110, 16, v68
    v_and_b32 v111, 0xffff0000, v68
    v_add_f32 v36, v36, v110
    v_add_f32 v37, v37, v111
    v_lshlrev_b32 v110, 16, v69
    v_and_b32 v111, 0xffff0000, v69
    v_add_f32 v38, v38, v110
    v_add_f32 v39, v39, v111
    v_lshlrev_b32 v110, 16, v70
    v_and_b32 v111, 0xffff0000, v70
    v_add_f32 v40, v40, v110
    v_add_f32 v41, v41, v111
    v_lshlrev_b32 v110, 16, v71
    v_and_b32 v111, 0xffff0000, v71
    v_add_f32 v42, v42, v110
    v_add_f32 v43, v43, v111
    v_lshlrev_b32 v110, 16, v72
    v_and_b32 v111, 0xffff0000, v72
    v_add_f32 v44, v44, v110
    v_add_f32 v45, v45, v111
    v_lshlrev_b32 v110, 16, v73
    v_and_b32 v111, 0xffff0000, v73
    v_add_f32 v46, v46, v110
    v_add_f32 v47, v47, v111
    v_lshlrev_b32 v110, 16, v74
    v_and_b32 v111, 0xffff0000, v74
    v_add_f32 v48, v48, v110
    v_add_f32 v49, v49, v111
    v_lshlrev_b32 v110, 16, v75
    v_and_b32 v111, 0xffff0000, v75
    v_add_f32 v50, v50, v110
    v_add_f32 v51, v51, v111
    s_waitcnt vmcnt(0)
    v_lshlrev_b32 v110, 16, v84
    v_and_b32 v111, 0xffff0000, v84
    v_add_f32 v36, v36, v110
    v_add_f32 v37, v37, v111
    v_lshlrev_b32 v110, 16, v85
    v_and_b32 v111, 0xffff0000, v85
    v_add_f32 v38, v38, v110
    v_add_f32 v39, v39, v111
    v_lshlrev_b32 v110, 16, v86
    v_and_b32 v111, 0xffff0000, v86
    v_add_f32 v40, v40, v110
    v_add_f32 v41, v41, v111
    v_lshlrev_b32 v110, 16, v87
    v_and_b32 v111, 0xffff0000, v87
    v_add_f32 v42, v42, v110
    v_add_f32 v43, v43, v111
    v_lshlrev_b32 v110, 16, v88
    v_and_b32 v111, 0xffff0000, v88
    v_add_f32 v44, v44, v110
    v_add_f32 v45, v45, v111
    v_lshlrev_b32 v110, 16, v89
    v_and_b32 v111, 0xffff0000, v89
    v_add_f32 v46, v46, v110
    v_add_f32 v47, v47, v111
    v_lshlrev_b32 v110, 16, v90
    v_and_b32 v111, 0xffff0000, v90
    v_add_f32 v48, v48, v110
    v_add_f32 v49, v49, v111
    v_lshlrev_b32 v110, 16, v91
    v_and_b32 v111, 0xffff0000, v91
    v_add_f32 v50, v50, v110
    v_add_f32 v51, v51, v111
    v_cvt_pk_bf16_f32 v128, v36, v37
    v_cvt_pk_bf16_f32 v129, v38, v39
    buffer_store_dwordx2 v[128:129], v109, s[64:67], s36 offen offset:0
    v_cvt_pk_bf16_f32 v130, v40, v41
    v_cvt_pk_bf16_f32 v131, v42, v43
    buffer_store_dwordx2 v[130:131], v109, s[64:67], s36 offen offset:16
    v_cvt_pk_bf16_f32 v132, v44, v45
    v_cvt_pk_bf16_f32 v133, v46, v47
    buffer_store_dwordx2 v[132:133], v109, s[64:67], s36 offen offset:32
    v_cvt_pk_bf16_f32 v134, v48, v49
    v_cvt_pk_bf16_f32 v135, v50, v51
    buffer_store_dwordx2 v[134:135], v109, s[64:67], s36 offen offset:48
    s_endpgm
L_g2_fin1:
    s_add_u32 s30, s38, 2
    s_lshl_b32 s30, s30, 13
    s_add_u32 s30, s30, s31

    buffer_load_dwordx4 v[68:71], v108, s[32:35], s30 offen sc1
    buffer_load_dwordx4 v[72:75], v108, s[32:35], s30 offen offset:1024 sc1
    s_add_u32 s30, s38, 3
    s_lshl_b32 s30, s30, 13
    s_add_u32 s30, s30, s31

    buffer_load_dwordx4 v[84:87], v108, s[32:35], s30 offen sc1
    buffer_load_dwordx4 v[88:91], v108, s[32:35], s30 offen offset:1024 sc1
    s_add_u32 s30, s38, 0
    s_lshl_b32 s30, s30, 13
    s_add_u32 s30, s30, s31

    buffer_load_dwordx4 v[36:39], v108, s[32:35], s30 offen sc1
    buffer_load_dwordx4 v[40:43], v108, s[32:35], s30 offen offset:1024 sc1
    s_waitcnt vmcnt(6)
    v_lshlrev_b32 v110, 16, v128
    v_and_b32 v111, 0xffff0000, v128
    v_add_f32 v52, v52, v110
    v_add_f32 v53, v53, v111
    v_lshlrev_b32 v110, 16, v129
    v_and_b32 v111, 0xffff0000, v129
    v_add_f32 v54, v54, v110
    v_add_f32 v55, v55, v111
    v_lshlrev_b32 v110, 16, v130
    v_and_b32 v111, 0xffff0000, v130
    v_add_f32 v56, v56, v110
    v_add_f32 v57, v57, v111
    v_lshlrev_b32 v110, 16, v131
    v_and_b32 v111, 0xffff0000, v131
    v_add_f32 v58, v58, v110
    v_add_f32 v59, v59, v111
    v_lshlrev_b32 v110, 16, v132
    v_and_b32 v111, 0xffff0000, v132
    v_add_f32 v60, v60, v110
    v_add_f32 v61, v61, v111
    v_lshlrev_b32 v110, 16, v133
    v_and_b32 v111, 0xffff0000, v133
    v_add_f32 v62, v62, v110
    v_add_f32 v63, v63, v111
    v_lshlrev_b32 v110, 16, v134
    v_and_b32 v111, 0xffff0000, v134
    v_add_f32 v64, v64, v110
    v_add_f32 v65, v65, v111
    v_lshlrev_b32 v110, 16, v135
    v_and_b32 v111, 0xffff0000, v135
    v_add_f32 v66, v66, v110
    v_add_f32 v67, v67, v111
    s_waitcnt vmcnt(4)
    v_lshlrev_b32 v110, 16, v68
    v_and_b32 v111, 0xffff0000, v68
    v_add_f32 v52, v52, v110
    v_add_f32 v53, v53, v111
    v_lshlrev_b32 v110, 16, v69
    v_and_b32 v111, 0xffff0000, v69
    v_add_f32 v54, v54, v110
    v_add_f32 v55, v55, v111
    v_lshlrev_b32 v110, 16, v70
    v_and_b32 v111, 0xffff0000, v70
    v_add_f32 v56, v56, v110
    v_add_f32 v57, v57, v111
    v_lshlrev_b32 v110, 16, v71
    v_and_b32 v111, 0xffff0000, v71
    v_add_f32 v58, v58, v110
    v_add_f32 v59, v59, v111
    v_lshlrev_b32 v110, 16, v72
    v_and_b32 v111, 0xffff0000, v72
    v_add_f32 v60, v60, v110
    v_add_f32 v61, v61, v111
    v_lshlrev_b32 v110, 16, v73
    v_and_b32 v111, 0xffff0000, v73
    v_add_f32 v62, v62, v110
    v_add_f32 v63, v63, v111
    v_lshlrev_b32 v110, 16, v74
    v_and_b32 v111, 0xffff0000, v74
    v_add_f32 v64, v64, v110
    v_add_f32 v65, v65, v111
    v_lshlrev_b32 v110, 16, v75
    v_and_b32 v111, 0xffff0000, v75
    v_add_f32 v66, v66, v110
    v_add_f32 v67, v67, v111
    s_waitcnt vmcnt(2)
    v_lshlrev_b32 v110, 16, v84
    v_and_b32 v111, 0xffff0000, v84
    v_add_f32 v52, v52, v110
    v_add_f32 v53, v53, v111
    v_lshlrev_b32 v110, 16, v85
    v_and_b32 v111, 0xffff0000, v85
    v_add_f32 v54, v54, v110
    v_add_f32 v55, v55, v111
    v_lshlrev_b32 v110, 16, v86
    v_and_b32 v111, 0xffff0000, v86
    v_add_f32 v56, v56, v110
    v_add_f32 v57, v57, v111
    v_lshlrev_b32 v110, 16, v87
    v_and_b32 v111, 0xffff0000, v87
    v_add_f32 v58, v58, v110
    v_add_f32 v59, v59, v111
    v_lshlrev_b32 v110, 16, v88
    v_and_b32 v111, 0xffff0000, v88
    v_add_f32 v60, v60, v110
    v_add_f32 v61, v61, v111
    v_lshlrev_b32 v110, 16, v89
    v_and_b32 v111, 0xffff0000, v89
    v_add_f32 v62, v62, v110
    v_add_f32 v63, v63, v111
    v_lshlrev_b32 v110, 16, v90
    v_and_b32 v111, 0xffff0000, v90
    v_add_f32 v64, v64, v110
    v_add_f32 v65, v65, v111
    v_lshlrev_b32 v110, 16, v91
    v_and_b32 v111, 0xffff0000, v91
    v_add_f32 v66, v66, v110
    v_add_f32 v67, v67, v111
    s_waitcnt vmcnt(0)
    v_lshlrev_b32 v110, 16, v36
    v_and_b32 v111, 0xffff0000, v36
    v_add_f32 v52, v52, v110
    v_add_f32 v53, v53, v111
    v_lshlrev_b32 v110, 16, v37
    v_and_b32 v111, 0xffff0000, v37
    v_add_f32 v54, v54, v110
    v_add_f32 v55, v55, v111
    v_lshlrev_b32 v110, 16, v38
    v_and_b32 v111, 0xffff0000, v38
    v_add_f32 v56, v56, v110
    v_add_f32 v57, v57, v111
    v_lshlrev_b32 v110, 16, v39
    v_and_b32 v111, 0xffff0000, v39
    v_add_f32 v58, v58, v110
    v_add_f32 v59, v59, v111
    v_lshlrev_b32 v110, 16, v40
    v_and_b32 v111, 0xffff0000, v40
    v_add_f32 v60, v60, v110
    v_add_f32 v61, v61, v111
    v_lshlrev_b32 v110, 16, v41
    v_and_b32 v111, 0xffff0000, v41
    v_add_f32 v62, v62, v110
    v_add_f32 v63, v63, v111
    v_lshlrev_b32 v110, 16, v42
    v_and_b32 v111, 0xffff0000, v42
    v_add_f32 v64, v64, v110
    v_add_f32 v65, v65, v111
    v_lshlrev_b32 v110, 16, v43
    v_and_b32 v111, 0xffff0000, v43
    v_add_f32 v66, v66, v110
    v_add_f32 v67, v67, v111
    v_cvt_pk_bf16_f32 v128, v52, v53
    v_cvt_pk_bf16_f32 v129, v54, v55
    buffer_store_dwordx2 v[128:129], v109, s[64:67], s36 offen offset:0
    v_cvt_pk_bf16_f32 v130, v56, v57
    v_cvt_pk_bf16_f32 v131, v58, v59
    buffer_store_dwordx2 v[130:131], v109, s[64:67], s36 offen offset:16
    v_cvt_pk_bf16_f32 v132, v60, v61
    v_cvt_pk_bf16_f32 v133, v62, v63
    buffer_store_dwordx2 v[132:133], v109, s[64:67], s36 offen offset:32
    v_cvt_pk_bf16_f32 v134, v64, v65
    v_cvt_pk_bf16_f32 v135, v66, v67
    buffer_store_dwordx2 v[134:135], v109, s[64:67], s36 offen offset:48
    s_endpgm
L_g2_fin2:
    s_add_u32 s30, s38, 3
    s_lshl_b32 s30, s30, 13
    s_add_u32 s30, s30, s31

    buffer_load_dwordx4 v[84:87], v108, s[32:35], s30 offen sc1
    buffer_load_dwordx4 v[88:91], v108, s[32:35], s30 offen offset:1024 sc1
    s_add_u32 s30, s38, 0
    s_lshl_b32 s30, s30, 13
    s_add_u32 s30, s30, s31

    buffer_load_dwordx4 v[36:39], v108, s[32:35], s30 offen sc1
    buffer_load_dwordx4 v[40:43], v108, s[32:35], s30 offen offset:1024 sc1
    s_add_u32 s30, s38, 1
    s_lshl_b32 s30, s30, 13
    s_add_u32 s30, s30, s31

    buffer_load_dwordx4 v[52:55], v108, s[32:35], s30 offen sc1
    buffer_load_dwordx4 v[56:59], v108, s[32:35], s30 offen offset:1024 sc1
    s_waitcnt vmcnt(6)
    v_lshlrev_b32 v110, 16, v128
    v_and_b32 v111, 0xffff0000, v128
    v_add_f32 v68, v68, v110
    v_add_f32 v69, v69, v111
    v_lshlrev_b32 v110, 16, v129
    v_and_b32 v111, 0xffff0000, v129
    v_add_f32 v70, v70, v110
    v_add_f32 v71, v71, v111
    v_lshlrev_b32 v110, 16, v130
    v_and_b32 v111, 0xffff0000, v130
    v_add_f32 v72, v72, v110
    v_add_f32 v73, v73, v111
    v_lshlrev_b32 v110, 16, v131
    v_and_b32 v111, 0xffff0000, v131
    v_add_f32 v74, v74, v110
    v_add_f32 v75, v75, v111
    v_lshlrev_b32 v110, 16, v132
    v_and_b32 v111, 0xffff0000, v132
    v_add_f32 v76, v76, v110
    v_add_f32 v77, v77, v111
    v_lshlrev_b32 v110, 16, v133
    v_and_b32 v111, 0xffff0000, v133
    v_add_f32 v78, v78, v110
    v_add_f32 v79, v79, v111
    v_lshlrev_b32 v110, 16, v134
    v_and_b32 v111, 0xffff0000, v134
    v_add_f32 v80, v80, v110
    v_add_f32 v81, v81, v111
    v_lshlrev_b32 v110, 16, v135
    v_and_b32 v111, 0xffff0000, v135
    v_add_f32 v82, v82, v110
    v_add_f32 v83, v83, v111
    s_waitcnt vmcnt(4)
    v_lshlrev_b32 v110, 16, v84
    v_and_b32 v111, 0xffff0000, v84
    v_add_f32 v68, v68, v110
    v_add_f32 v69, v69, v111
    v_lshlrev_b32 v110, 16, v85
    v_and_b32 v111, 0xffff0000, v85
    v_add_f32 v70, v70, v110
    v_add_f32 v71, v71, v111
    v_lshlrev_b32 v110, 16, v86
    v_and_b32 v111, 0xffff0000, v86
    v_add_f32 v72, v72, v110
    v_add_f32 v73, v73, v111
    v_lshlrev_b32 v110, 16, v87
    v_and_b32 v111, 0xffff0000, v87
    v_add_f32 v74, v74, v110
    v_add_f32 v75, v75, v111
    v_lshlrev_b32 v110, 16, v88
    v_and_b32 v111, 0xffff0000, v88
    v_add_f32 v76, v76, v110
    v_add_f32 v77, v77, v111
    v_lshlrev_b32 v110, 16, v89
    v_and_b32 v111, 0xffff0000, v89
    v_add_f32 v78, v78, v110
    v_add_f32 v79, v79, v111
    v_lshlrev_b32 v110, 16, v90
    v_and_b32 v111, 0xffff0000, v90
    v_add_f32 v80, v80, v110
    v_add_f32 v81, v81, v111
    v_lshlrev_b32 v110, 16, v91
    v_and_b32 v111, 0xffff0000, v91
    v_add_f32 v82, v82, v110
    v_add_f32 v83, v83, v111
    s_waitcnt vmcnt(2)
    v_lshlrev_b32 v110, 16, v36
    v_and_b32 v111, 0xffff0000, v36
    v_add_f32 v68, v68, v110
    v_add_f32 v69, v69, v111
    v_lshlrev_b32 v110, 16, v37
    v_and_b32 v111, 0xffff0000, v37
    v_add_f32 v70, v70, v110
    v_add_f32 v71, v71, v111
    v_lshlrev_b32 v110, 16, v38
    v_and_b32 v111, 0xffff0000, v38
    v_add_f32 v72, v72, v110
    v_add_f32 v73, v73, v111
    v_lshlrev_b32 v110, 16, v39
    v_and_b32 v111, 0xffff0000, v39
    v_add_f32 v74, v74, v110
    v_add_f32 v75, v75, v111
    v_lshlrev_b32 v110, 16, v40
    v_and_b32 v111, 0xffff0000, v40
    v_add_f32 v76, v76, v110
    v_add_f32 v77, v77, v111
    v_lshlrev_b32 v110, 16, v41
    v_and_b32 v111, 0xffff0000, v41
    v_add_f32 v78, v78, v110
    v_add_f32 v79, v79, v111
    v_lshlrev_b32 v110, 16, v42
    v_and_b32 v111, 0xffff0000, v42
    v_add_f32 v80, v80, v110
    v_add_f32 v81, v81, v111
    v_lshlrev_b32 v110, 16, v43
    v_and_b32 v111, 0xffff0000, v43
    v_add_f32 v82, v82, v110
    v_add_f32 v83, v83, v111
    s_waitcnt vmcnt(0)
    v_lshlrev_b32 v110, 16, v52
    v_and_b32 v111, 0xffff0000, v52
    v_add_f32 v68, v68, v110
    v_add_f32 v69, v69, v111
    v_lshlrev_b32 v110, 16, v53
    v_and_b32 v111, 0xffff0000, v53
    v_add_f32 v70, v70, v110
    v_add_f32 v71, v71, v111
    v_lshlrev_b32 v110, 16, v54
    v_and_b32 v111, 0xffff0000, v54
    v_add_f32 v72, v72, v110
    v_add_f32 v73, v73, v111
    v_lshlrev_b32 v110, 16, v55
    v_and_b32 v111, 0xffff0000, v55
    v_add_f32 v74, v74, v110
    v_add_f32 v75, v75, v111
    v_lshlrev_b32 v110, 16, v56
    v_and_b32 v111, 0xffff0000, v56
    v_add_f32 v76, v76, v110
    v_add_f32 v77, v77, v111
    v_lshlrev_b32 v110, 16, v57
    v_and_b32 v111, 0xffff0000, v57
    v_add_f32 v78, v78, v110
    v_add_f32 v79, v79, v111
    v_lshlrev_b32 v110, 16, v58
    v_and_b32 v111, 0xffff0000, v58
    v_add_f32 v80, v80, v110
    v_add_f32 v81, v81, v111
    v_lshlrev_b32 v110, 16, v59
    v_and_b32 v111, 0xffff0000, v59
    v_add_f32 v82, v82, v110
    v_add_f32 v83, v83, v111
    v_cvt_pk_bf16_f32 v128, v68, v69
    v_cvt_pk_bf16_f32 v129, v70, v71
    buffer_store_dwordx2 v[128:129], v109, s[64:67], s36 offen offset:0
    v_cvt_pk_bf16_f32 v130, v72, v73
    v_cvt_pk_bf16_f32 v131, v74, v75
    buffer_store_dwordx2 v[130:131], v109, s[64:67], s36 offen offset:16
    v_cvt_pk_bf16_f32 v132, v76, v77
    v_cvt_pk_bf16_f32 v133, v78, v79
    buffer_store_dwordx2 v[132:133], v109, s[64:67], s36 offen offset:32
    v_cvt_pk_bf16_f32 v134, v80, v81
    v_cvt_pk_bf16_f32 v135, v82, v83
    buffer_store_dwordx2 v[134:135], v109, s[64:67], s36 offen offset:48
    s_endpgm
L_g2_end:
    s_endpgm
.section .rodata,"a"
.p2align 6
.amdhsa_kernel prep_kernel
  .amdhsa_next_free_vgpr 40
  .amdhsa_next_free_sgpr 96
  .amdhsa_accum_offset 40
  .amdhsa_group_segment_fixed_size 0
  .amdhsa_kernarg_size 96
  .amdhsa_user_sgpr_count 2
  .amdhsa_user_sgpr_kernarg_segment_ptr 1
  .amdhsa_system_sgpr_workgroup_id_x 1
  .amdhsa_float_denorm_mode_32 3
.end_amdhsa_kernel
.p2align 6
.amdhsa_kernel gemm1_kernel
  .amdhsa_next_free_vgpr 220
  .amdhsa_next_free_sgpr 96
  .amdhsa_accum_offset 220
  .amdhsa_group_segment_fixed_size 0
  .amdhsa_kernarg_size 96
  .amdhsa_user_sgpr_count 2
  .amdhsa_user_sgpr_kernarg_segment_ptr 1
  .amdhsa_system_sgpr_workgroup_id_x 1
  .amdhsa_float_denorm_mode_32 3
.end_amdhsa_kernel
.p2align 6
.amdhsa_kernel gemm2_kernel
  .amdhsa_next_free_vgpr 136
  .amdhsa_next_free_sgpr 96
  .amdhsa_accum_offset 136
  .amdhsa_group_segment_fixed_size 0
  .amdhsa_kernarg_size 96
  .amdhsa_user_sgpr_count 2
  .amdhsa_user_sgpr_kernarg_segment_ptr 1
  .amdhsa_system_sgpr_workgroup_id_x 1
  .amdhsa_float_denorm_mode_32 3
.end_amdhsa_kernel
```
